```python
import torch

def _softmax(x, axis=-1):
    return torch.softmax(x, dim=axis)
def _gelu(x):
    return torch.nn.functional.gelu(x, approximate="tanh")
def _silu(x):
    return torch.nn.functional.silu(x)
def _sigmoid(x):
    return torch.sigmoid(x)
def _layernorm(x, axis=-1, eps=1e-5):
    m = x.mean(dim=axis, keepdim=True)
    v = x.var(dim=axis, keepdim=True, unbiased=False)
    return (x - m) / torch.sqrt(v + eps)
def _scatter_add(tgt, idx, src, axis=0):
    return tgt.clone().index_add_(axis, idx, src)
def _segment_sum(src, seg, n):
    out = torch.zeros((n,) + src.shape[1:], dtype=src.dtype)
    return out.index_add_(0, seg, src)
def _pad(x, pw):
    flat = tuple(v for pair in reversed(pw) for v in pair)
    return torch.nn.functional.pad(x, flat)

kernel_name = 'recurrent_scan__ssm_conv_s4__dense_activation_silu__prompt'

def setup_inputs():

    _w = (lambda a: (lambda t: t.to(torch.bfloat16) if t.is_floating_point() else t)(torch.as_tensor(a)))
    def _A_setup():
        B, L, D, N = 1, 2048, 512, 128
        A_re = -(lambda _x: torch.exp(torch.as_tensor(_x)))((lambda *s: torch.randn(*s, dtype=torch.bfloat16) * 3.2)(D, N))
        A_im = torch.pi * (lambda *s: torch.randn(*s, dtype=torch.bfloat16) * 0.2)(D, N)
        B_re = (lambda *s: torch.randn(*s, dtype=torch.bfloat16) * 0.2)(D, N)
        B_im = (lambda *s: torch.randn(*s, dtype=torch.bfloat16) * 0.2)(D, N)
        C_re = (lambda *s: torch.randn(*s, dtype=torch.bfloat16) * 0.2)(D, N)
        C_im = (lambda *s: torch.randn(*s, dtype=torch.bfloat16) * 0.2)(D, N)
        log_dt = (lambda *s: torch.randn(*s, dtype=torch.bfloat16) * 0.2)(D) * 0.5 - 4.0
        Dskip = (lambda *s: torch.randn(*s, dtype=torch.bfloat16) * 0.2)(D)
        return {
            "u": _w((lambda *s: torch.randn(*s, dtype=torch.bfloat16) * 0.05)(B, L, D)),
            "A_re": _w(A_re),
            "A_im": _w(A_im),
            "B_re": _w(B_re),
            "B_im": _w(B_im),
            "C_re": _w(C_re),
            "C_im": _w(C_im),
            "log_dt": _w(log_dt),
            "Dskip": _w(Dskip),
        }
    _A_in = _A_setup()

    def _B_setup():
        B, S, D, F = 1, 2048, 512, 1792
        return {
            "x": _w((lambda *s: torch.randn(*s, dtype=torch.bfloat16) * 0.05)(B, S, D)),
            "w1": _w((lambda *s: torch.randn(*s, dtype=torch.bfloat16) * 0.8)(D, F) * (D ** -0.5)),
            "w2": _w((lambda *s: torch.randn(*s, dtype=torch.bfloat16) * 0.1)(F, D) * (F ** -0.5)),
        }
    _B_in = _B_setup()

    return {
        "A_u": _A_in["u"],
        "A_A_re": _A_in["A_re"],
        "A_A_im": _A_in["A_im"],
        "A_B_re": _A_in["B_re"],
        "A_B_im": _A_in["B_im"],
        "A_C_re": _A_in["C_re"],
        "A_C_im": _A_in["C_im"],
        "A_log_dt": _A_in["log_dt"],
        "A_Dskip": _A_in["Dskip"],
        "B_x": _B_in["x"],
        "B_w1": _B_in["w1"],
        "B_w2": _B_in["w2"],
    }

def reference(A_u, A_A_re, A_A_im, A_B_re, A_B_im, A_C_re, A_C_im, A_log_dt, A_Dskip, B_x, B_w1, B_w2):
    def _A_ref(u, A_re, A_im, B_re, B_im, C_re, C_im, log_dt, Dskip):
        Bsz, L, D = u.shape
        dt = torch.exp(log_dt)[:, None]
        A = A_re + 1j * A_im
        Bc = B_re + 1j * B_im
        Cc = C_re + 1j * C_im
        logdA = dt * A
        dB = dt * Bc
        l = (lambda x, dt: x.to(dt))(torch.arange(L), A_re.dtype)
        P = torch.exp(logdA[:, :, None] * l[None, None, :])
        K = torch.einsum("dn,dnl,dn->dl", Cc, P, dB).real
        L2 = 2 * L
        Kp = _pad(K, ((0, 0), (0, L)))
        up = (lambda x, *d: x.permute(*d))(u, 0, 2, 1)
        up = _pad(up, ((0, 0), (0, 0), (0, L)))
        Kf = (lambda x, axes=(-2,-1): torch.fft.rfft2(x.float(), dim=axes))(Kp[:, None, :], axes=(-2, -1))
        Uf = (lambda x, axes=(-2,-1): torch.fft.rfft2(x.float(), dim=axes))(up[:, :, None, :], axes=(-2, -1))
        Yf = Uf * Kf[None, :, :, :]
        y = (lambda x, s, axes=(-2,-1): torch.fft.irfft2(x, s=s, dim=axes).to(torch.bfloat16))(Yf, (1, L2), axes=(-2, -1))[:, :, 0, :L]
        y = (lambda x, *d: x.permute(*d))(y, 0, 2, 1) + u * Dskip[None, None, :]
        return y

    def _B_ref(x, w1, w2):
        h = torch.einsum("bsd,df->bsf", x, w1)
        h = _silu(h)
        out = torch.einsum("bsf,fd->bsd", h, w2)
        return out

    x = A_u
    xn = _layernorm(x, axis=-1)
    s = _A_ref(xn, A_A_re, A_A_im, A_B_re, A_B_im, A_C_re, A_C_im, A_log_dt, A_Dskip)
    g = _silu(_B_ref(xn, B_w1, B_w2))
    return x + s * g
```

```asm
; @launch grid=(256,1,1) block=(256,1,1) lds=163840
.amdgcn_target "amdgcn-amd-amdhsa--gfx950"
.text
.globl recurrent_scan__ssm_conv_s4__dense_activation_silu__prompt_kernel
.p2align 8
.type recurrent_scan__ssm_conv_s4__dense_activation_silu__prompt_kernel,@function
recurrent_scan__ssm_conv_s4__dense_activation_silu__prompt_kernel:
s_cmp_ge_u32 s2, 256
s_cbranch_scc1 L_end
s_load_dwordx16 s[4:19], s[0:1], 0
s_load_dwordx8 s[20:27], s[0:1], 64
s_load_dwordx4 s[28:31], s[0:1], 96
s_load_dwordx2 s[32:33], s[0:1], 112
s_getpc_b64 s[72:73]
L_here_1:
s_sub_u32 s72, s72, L_here_1 - recurrent_scan__ssm_conv_s4__dense_activation_silu__prompt_kernel
s_subb_u32 s73, s73, 0
s_lshr_b32 s57, s2, 3
s_and_b32 s57, s57, 7
s_lshl_b32 s57, s57, 12
v_lshlrev_b32 v3, 4, v0
v_add_u32 v3, s57, v3
v_min_u32 v3, L_codeend - recurrent_scan__ssm_conv_s4__dense_activation_silu__prompt_kernel - 16, v3
global_load_dwordx4 v[4:7], v3, s[72:73]
s_and_b32 s34, s2, 7
s_lshr_b32 s35, s2, 3
s_lshr_b32 s57, s34, 1
s_lshl_b32 s57, s57, 2
s_and_b32 s52, s35, 3
s_add_u32 s52, s52, s57
s_lshr_b32 s60, s35, 2
s_and_b32 s57, s34, 1
s_mul_i32 s53, s57, 7
s_add_u32 s53, s53, s60
s_lshl_b32 s57, s57, 3
s_add_u32 s57, s57, s60
s_lshl_b32 s55, s52, 4
s_add_u32 s55, s55, s57
s_cmp_eq_u32 s60, 7
s_cselect_b32 s56, 1, 0
v_and_b32 v1, 63, v0
v_lshrrev_b32 v2, 6, v0
s_nop 0
v_readfirstlane_b32 s54, v2
v_lshlrev_b32 v2, 4, v1
v_lshrrev_b32 v16, 3, v1
v_lshlrev_b32 v16, 10, v16
v_and_b32 v17, 7, v1
v_lshrrev_b32 v18, 4, v1
v_xor_b32 v17, v17, v18
v_lshlrev_b32 v17, 4, v17
v_add_u32 v8, v16, v17
v_xor_b32 v9, 64, v8
v_mul_u32_u24 v16, 3584, v18
v_and_b32 v17, 15, v1
v_lshlrev_b32 v18, 2, v18
v_xor_b32 v17, v17, v18
v_lshlrev_b32 v17, 4, v17
v_add_u32 v12, v16, v17
v_add_u32 v10, 14336, v8
v_add_u32 v11, 21504, v9
v_add_u32 v9, 7168, v9
v_add_u32 v13, 13312, v12
v_add_u32 v14, 26624, v12
v_add_u32 v15, 39936, v12
s_lshl_b32 s69, s54, 12
s_lshl_b32 s76, s52, 17
s_lshl_b32 s57, s54, 15
s_add_u32 s76, s76, s57
s_mul_i32 s77, s54, 57344
s_lshl_b32 s57, s53, 8
s_add_u32 s77, s77, s57
s_lshr_b32 s78, s54, 1
s_and_b32 s79, s54, 1
s_lshl_b32 s80, s34, 6
s_lshl_b32 s57, s35, 1
s_add_u32 s80, s80, s57
s_lshr_b32 s81, s54, 1
s_and_b32 s82, s54, 1
s_add_u32 s83, s80, s81
s_and_b32 s84, s35, 3
s_lshl_b32 s57, s34, 2
s_add_u32 s84, s84, s57
s_lshr_b32 s85, s35, 2
s_mul_i32 s86, s54, 458752
s_lshl_b32 s57, s85, 7
s_add_u32 s86, s86, s57
s_lshl_b32 s87, s54, 13
s_lshr_b32 s57, s35, 2
s_and_b32 s60, s35, 3
s_lshl_b32 s60, s60, 1
s_add_u32 s57, s57, s60
s_and_b32 s88, s57, 7
s_sub_u32 s60, s57, 7
s_cmp_ge_u32 s57, 7
s_cselect_b32 s89, s60, s57
s_waitcnt lgkmcnt(0)
v_mov_b32 v16, 0
global_load_dword v17, v16, s[4:5]
global_load_dword v17, v16, s[24:25]
global_load_dword v17, v16, s[26:27]
s_mov_b32 s36, s4
s_and_b32 s37, s5, 0xffff
s_mov_b32 s38, 2097152
s_mov_b32 s39, 0x20000
s_lshl_b32 s93, s55, 3
s_lshl_b32 s57, s54, 1
s_add_u32 s93, s93, s57
s_lshl_b32 s57, s93, 10
buffer_load_dwordx4 v[20:23], v2, s[36:39], s57 offen
buffer_load_dwordx4 v[24:27], v2, s[36:39], s57 offen offset:1024
s_mov_b32 s40, s24
s_and_b32 s41, s25, 0xffff
s_mov_b32 s42, 1835008
s_mov_b32 s43, 0x20000
s_add_u32 s90, s88, 0
s_and_b32 s90, s90, 7
s_add_u32 m0, s69, 0
s_mul_i32 s91, s90, 229376
s_lshl_b32 s90, s90, 7
s_add_u32 s90, s90, s76
s_add_u32 s91, s91, s77
buffer_load_dwordx4 v8, s[36:39], s90 offen offset:0 lds
buffer_load_dwordx4 v9, s[36:39], s90 offen offset:1024 lds
buffer_load_dwordx4 v10, s[36:39], s90 offen offset:2048 lds
buffer_load_dwordx4 v11, s[36:39], s90 offen offset:3072 lds
s_add_u32 m0, s69, 16384
s_nop 0
buffer_load_dwordx4 v12, s[40:43], s91 offen offset:0 lds
buffer_load_dwordx4 v13, s[40:43], s91 offen offset:1024 lds
buffer_load_dwordx4 v14, s[40:43], s91 offen offset:2048 lds
buffer_load_dwordx4 v15, s[40:43], s91 offen offset:3072 lds
s_mov_b32 s48, s32
s_and_b32 s49, s33, 0xffff
s_mov_b32 s50, 16777216
s_mov_b32 s51, 0x20000
s_mov_b32 s44, s26
s_and_b32 s45, s27, 0xffff
s_mov_b32 s46, 1835008
s_mov_b32 s47, 0x20000
s_or_b32 s57, s2, s54
s_cmp_eq_u32 s57, 0
s_cbranch_scc1 L_non_2
L_nonb_3:
v_and_b32 v38, 31, v1
v_lshrrev_b32 v39, 1, v38
v_and_b32 v39, 7, v39
v_lshrrev_b32 v40, 5, v1
v_xor_b32 v39, v39, v40
s_lshl_b32 s57, s79, 13
v_lshlrev_b32 v38, 7, v38
v_add_u32 v38, s57, v38
v_xor_b32 v40, 0, v39
v_lshlrev_b32 v40, 4, v40
v_add_u32 v18, v38, v40
v_add_u32 v30, 0x10000, v18
v_xor_b32 v40, 2, v39
v_lshlrev_b32 v40, 4, v40
v_add_u32 v19, v38, v40
v_add_u32 v31, 0x10000, v19
v_xor_b32 v40, 4, v39
v_lshlrev_b32 v40, 4, v40
v_add_u32 v28, v38, v40
v_add_u32 v32, 0x10000, v28
v_xor_b32 v40, 6, v39
v_lshlrev_b32 v40, 4, v40
v_add_u32 v29, v38, v40
v_add_u32 v33, 0x10000, v29
v_lshrrev_b32 v38, 5, v1
v_lshlrev_b32 v38, 3, v38
v_lshrrev_b32 v39, 2, v1
v_and_b32 v39, 3, v39
v_add_u32 v38, v38, v39
v_lshlrev_b32 v38, 8, v38
v_lshrrev_b32 v40, 4, v1
v_and_b32 v40, 1, v40
v_lshlrev_b32 v40, 5, v40
v_add_u32 v38, v38, v40
v_and_b32 v40, 3, v1
v_lshlrev_b32 v40, 3, v40
v_add_u32 v38, v38, v40
v_add_u32 v38, 16384, v38
s_lshl_b32 s57, s78, 1
s_xor_b32 s60, s79, 0
s_add_u32 s60, s57, s60
v_xor_b32 v40, s60, v39
v_lshlrev_b32 v40, 6, v40
v_add_u32 v34, v38, v40
v_add_u32 v36, 0x10000, v34
s_xor_b32 s60, s79, 1
s_add_u32 s60, s57, s60
v_xor_b32 v40, s60, v39
v_lshlrev_b32 v40, 6, v40
v_add_u32 v35, v38, v40
v_add_u32 v37, 0x10000, v35
v_and_b32 v38, 15, v1
v_lshrrev_b32 v39, 4, v1
v_and_b32 v39, 1, v39
v_cmp_eq_u32 vcc, v38, v39
v_mov_b32 v40, 0x3f803f80
s_nop 0
v_cndmask_b32 v44, 0, v40, vcc
v_mov_b32 v45, v44
v_mov_b32 v46, v44
v_mov_b32 v47, v44
v_lshlrev_b32 v56, 3, v0
v_sub_u32 v56, 2048, v56
v_add_u32 v54, 4, v56
v_add_u32 v55, 3, v56
v_min_u32 v54, 2048, v54
v_min_u32 v55, 2048, v55
v_cvt_f32_u32 v54, v54
v_cvt_f32_u32 v55, v55
v_cvt_pk_bf16_f32 v54, v54, v55
v_and_b32 v55, 0xffff0000, v54
v_lshlrev_b32 v54, 16, v54
v_cvt_u32_f32 v54, v54
v_cvt_u32_f32 v55, v55
v_add_u32 v54, 1, v54
v_add_u32 v55, 1, v55
v_bfe_u32 v38, v54, 6, 2
v_bfe_u32 v39, v55, 6, 2
v_lshlrev_b32 v38, 1, v38
v_lshlrev_b32 v39, 1, v39
v_xor_b32 v54, v54, v38
v_xor_b32 v55, v55, v39
v_lshlrev_b32 v54, 1, v54
v_lshlrev_b32 v55, 1, v55
v_add_u32 v38, 89600, v54
v_add_u32 v39, 89600, v55
v_add_u32 v54, 2, v56
v_add_u32 v55, 1, v56
v_min_u32 v54, 2048, v54
v_min_u32 v55, 2048, v55
v_cvt_f32_u32 v54, v54
v_cvt_f32_u32 v55, v55
v_cvt_pk_bf16_f32 v54, v54, v55
v_and_b32 v55, 0xffff0000, v54
v_lshlrev_b32 v54, 16, v54
v_cvt_u32_f32 v54, v54
v_cvt_u32_f32 v55, v55
v_add_u32 v54, 1, v54
v_add_u32 v55, 1, v55
v_bfe_u32 v40, v54, 6, 2
v_bfe_u32 v41, v55, 6, 2
v_lshlrev_b32 v40, 1, v40
v_lshlrev_b32 v41, 1, v41
v_xor_b32 v54, v54, v40
v_xor_b32 v55, v55, v41
v_lshlrev_b32 v54, 1, v54
v_lshlrev_b32 v55, 1, v55
v_add_u32 v40, 89600, v54
v_add_u32 v41, 89600, v55
v_add_u32 v54, 0, v56
v_add_u32 v55, -1, v56
v_min_u32 v54, 2048, v54
v_min_u32 v55, 2048, v55
v_cvt_f32_u32 v54, v54
v_cvt_f32_u32 v55, v55
v_cvt_pk_bf16_f32 v54, v54, v55
v_and_b32 v55, 0xffff0000, v54
v_lshlrev_b32 v54, 16, v54
v_cvt_u32_f32 v54, v54
v_cvt_u32_f32 v55, v55
v_add_u32 v54, 1, v54
v_add_u32 v55, 1, v55
v_bfe_u32 v42, v54, 6, 2
v_bfe_u32 v43, v55, 6, 2
v_lshlrev_b32 v42, 1, v42
v_lshlrev_b32 v43, 1, v43
v_xor_b32 v54, v54, v42
v_xor_b32 v55, v55, v43
v_lshlrev_b32 v54, 1, v54
v_lshlrev_b32 v55, 1, v55
v_add_u32 v42, 89600, v54
v_add_u32 v43, 89600, v55
v_add_u32 v54, -2, v56
v_add_u32 v55, -3, v56
v_min_u32 v54, 2048, v54
v_min_u32 v55, 2048, v55
v_cvt_f32_u32 v54, v54
v_cvt_f32_u32 v55, v55
v_cvt_pk_bf16_f32 v54, v54, v55
v_and_b32 v55, 0xffff0000, v54
v_lshlrev_b32 v54, 16, v54
v_cvt_u32_f32 v54, v54
v_cvt_u32_f32 v55, v55
v_add_u32 v54, 1, v54
v_add_u32 v55, 1, v55
v_bfe_u32 v48, v54, 6, 2
v_bfe_u32 v49, v55, 6, 2
v_lshlrev_b32 v48, 1, v48
v_lshlrev_b32 v49, 1, v49
v_xor_b32 v54, v54, v48
v_xor_b32 v55, v55, v49
v_lshlrev_b32 v54, 1, v54
v_lshlrev_b32 v55, 1, v55
v_add_u32 v48, 89600, v54
v_add_u32 v49, 89600, v55
v_add_u32 v54, -4, v56
v_add_u32 v55, -5, v56
v_min_u32 v54, 2048, v54
v_min_u32 v55, 2048, v55
v_cvt_f32_u32 v54, v54
v_cvt_f32_u32 v55, v55
v_cvt_pk_bf16_f32 v54, v54, v55
v_and_b32 v55, 0xffff0000, v54
v_lshlrev_b32 v54, 16, v54
v_cvt_u32_f32 v54, v54
v_cvt_u32_f32 v55, v55
v_add_u32 v54, 1, v54
v_add_u32 v55, 1, v55
v_bfe_u32 v50, v54, 6, 2
v_bfe_u32 v51, v55, 6, 2
v_lshlrev_b32 v50, 1, v50
v_lshlrev_b32 v51, 1, v51
v_xor_b32 v54, v54, v50
v_xor_b32 v55, v55, v51
v_lshlrev_b32 v54, 1, v54
v_lshlrev_b32 v55, 1, v55
v_add_u32 v50, 89600, v54
v_add_u32 v51, 89600, v55
v_add_u32 v54, -6, v56
v_add_u32 v55, -7, v56
v_min_u32 v54, 2048, v54
v_min_u32 v55, 2048, v55
v_cvt_f32_u32 v54, v54
v_cvt_f32_u32 v55, v55
v_cvt_pk_bf16_f32 v54, v54, v55
v_and_b32 v55, 0xffff0000, v54
v_lshlrev_b32 v54, 16, v54
v_cvt_u32_f32 v54, v54
v_cvt_u32_f32 v55, v55
v_add_u32 v54, 1, v54
v_add_u32 v55, 1, v55
v_bfe_u32 v52, v54, 6, 2
v_bfe_u32 v53, v55, 6, 2
v_lshlrev_b32 v52, 1, v52
v_lshlrev_b32 v53, 1, v53
v_xor_b32 v54, v54, v52
v_xor_b32 v55, v55, v53
v_lshlrev_b32 v54, 1, v54
v_lshlrev_b32 v55, 1, v55
v_add_u32 v52, 89600, v54
v_add_u32 v53, 89600, v55
v_lshrrev_b32 v64, 3, v1
v_lshlrev_b32 v64, 10, v64
v_lshrrev_b32 v65, 4, v1
v_and_b32 v65, 1, v65
v_lshlrev_b32 v65, 2, v65
v_and_b32 v66, 7, v1
v_xor_b32 v65, v65, v66
v_lshlrev_b32 v65, 4, v65
v_add_u32 v54, v64, v65
v_lshrrev_b32 v64, 5, v1
v_lshlrev_b32 v64, 3, v64
v_lshrrev_b32 v65, 2, v1
v_and_b32 v65, 3, v65
v_add_u32 v64, v64, v65
v_lshlrev_b32 v64, 7, v64
v_lshrrev_b32 v66, 4, v1
v_and_b32 v66, 1, v66
v_lshlrev_b32 v66, 5, v66
v_add_u32 v64, v64, v66
v_and_b32 v66, 3, v1
v_lshlrev_b32 v66, 3, v66
v_add_u32 v64, v64, v66
v_add_u32 v64, s87, v64
v_lshrrev_b32 v65, 1, v65
s_lshr_b32 s57, s54, 1
v_xor_b32 v65, s57, v65
v_lshlrev_b32 v65, 6, v65
v_add_u32 v58, v64, v65
v_xor_b32 v65, 64, v65
v_add_u32 v59, v64, v65
v_add_u32 v60, 65536, v58
v_add_u32 v61, 65536, v59
v_add_u32 v62, 131072, v58
v_add_u32 v63, 131072, v59
v_add_u32 v55, 7168, v54
v_add_u32 v56, 14336, v54
v_add_u32 v57, 21504, v54
v_lshlrev_b32 v64, 2, v1
s_mul_i32 s57, s81, 28160
s_lshl_b32 s60, s82, 8
s_add_u32 s57, s57, s60
s_add_u32 s57, s57, 33280
v_add_u32 v67, s57, v64
v_and_b32 v64, 15, v1
v_lshrrev_b32 v65, 4, v1
v_xor_b32 v65, v65, v64
v_lshlrev_b32 v65, 4, v65
v_lshlrev_b32 v64, 9, v64
s_mul_i32 s57, s81, 28160
s_add_u32 s57, s57, 33280
v_add3_u32 v68, v64, v65, s57
s_cmp_eq_u32 s82, 0
s_cselect_b32 s61, 0, 1032
s_cselect_b32 s62, 8, 3072
s_cselect_b32 s63, 2, 512
v_lshrrev_b32 v66, 4, v1
v_mov_b32 v69, s61
v_mov_b32 v70, s63
v_mov_b32 v64, s62
v_cmp_eq_u32 vcc, 1, v66
s_nop 1
v_cndmask_b32 v69, v69, v64, vcc
v_mov_b32 v64, 512
v_mov_b32 v65, 4
v_cmp_eq_u32 vcc, 2, v66
s_nop 1
v_cndmask_b32 v69, v69, v64, vcc
v_cndmask_b32 v70, v70, v65, vcc
v_mov_b32 v64, 1024
v_mov_b32 v65, 512
v_cmp_eq_u32 vcc, 3, v66
s_nop 1
v_cndmask_b32 v69, v69, v64, vcc
v_cndmask_b32 v70, v70, v65, vcc
v_and_b32 v64, 15, v1
v_lshlrev_b32 v64, 4, v64
v_add_u32 v69, v69, v64
v_lshrrev_b32 v69, 1, v69
v_lshrrev_b32 v70, 1, v70
v_add_u32 v69, 1, v69
s_mul_i32 s57, s81, 4352
s_add_u32 s57, s57, 89600
s_add_u32 s60, s57, 4200
v_add_u32 v64, 0, v69
v_bfe_u32 v65, v64, 6, 2
v_lshlrev_b32 v65, 1, v65
v_xor_b32 v64, v64, v65
v_lshlrev_b32 v64, 1, v64
v_add_u32 v71, s57, v64
s_cmp_eq_u32 s82, 0
s_cselect_b32 s61, 64, 32
v_cmp_gt_u32 vcc, s61, v1
v_mov_b32 v65, s60
s_nop 0
v_cndmask_b32 v71, v65, v71, vcc
v_add_u32 v64, 128, v69
v_bfe_u32 v65, v64, 6, 2
v_lshlrev_b32 v65, 1, v65
v_xor_b32 v64, v64, v65
v_lshlrev_b32 v64, 1, v64
v_add_u32 v72, s57, v64
s_cmp_eq_u32 s82, 0
s_cselect_b32 s61, 64, 32
v_cmp_gt_u32 vcc, s61, v1
v_mov_b32 v65, s60
s_nop 0
v_cndmask_b32 v72, v65, v72, vcc
v_add_u32 v69, v69, v70
v_add_u32 v64, 0, v69
v_bfe_u32 v65, v64, 6, 2
v_lshlrev_b32 v65, 1, v65
v_xor_b32 v64, v64, v65
v_lshlrev_b32 v64, 1, v64
v_add_u32 v73, s57, v64
s_cmp_eq_u32 s82, 0
s_cselect_b32 s61, 64, 32
v_cmp_gt_u32 vcc, s61, v1
v_mov_b32 v65, s60
s_nop 0
v_cndmask_b32 v73, v65, v73, vcc
v_add_u32 v64, 128, v69
v_bfe_u32 v65, v64, 6, 2
v_lshlrev_b32 v65, 1, v65
v_xor_b32 v64, v64, v65
v_lshlrev_b32 v64, 1, v64
v_add_u32 v74, s57, v64
s_cmp_eq_u32 s82, 0
s_cselect_b32 s61, 64, 32
v_cmp_gt_u32 vcc, s61, v1
v_mov_b32 v65, s60
s_nop 0
v_cndmask_b32 v74, v65, v74, vcc
v_add_u32 v69, v69, v70
v_add_u32 v64, 0, v69
v_bfe_u32 v65, v64, 6, 2
v_lshlrev_b32 v65, 1, v65
v_xor_b32 v64, v64, v65
v_lshlrev_b32 v64, 1, v64
v_add_u32 v75, s57, v64
s_cmp_eq_u32 s82, 0
s_cselect_b32 s61, 64, 17
v_cmp_gt_u32 vcc, s61, v1
v_mov_b32 v65, s60
s_nop 0
v_cndmask_b32 v75, v65, v75, vcc
v_add_u32 v64, 128, v69
v_bfe_u32 v65, v64, 6, 2
v_lshlrev_b32 v65, 1, v65
v_xor_b32 v64, v64, v65
v_lshlrev_b32 v64, 1, v64
v_add_u32 v76, s57, v64
s_cmp_eq_u32 s82, 0
s_cselect_b32 s61, 64, 16
v_cmp_gt_u32 vcc, s61, v1
v_mov_b32 v65, s60
s_nop 0
v_cndmask_b32 v76, v65, v76, vcc
v_add_u32 v69, v69, v70
v_add_u32 v64, 0, v69
v_bfe_u32 v65, v64, 6, 2
v_lshlrev_b32 v65, 1, v65
v_xor_b32 v64, v64, v65
v_lshlrev_b32 v64, 1, v64
v_add_u32 v77, s57, v64
s_cmp_eq_u32 s82, 0
s_cselect_b32 s61, 64, 16
v_cmp_gt_u32 vcc, s61, v1
v_mov_b32 v65, s60
s_nop 0
v_cndmask_b32 v77, v65, v77, vcc
v_add_u32 v64, 128, v69
v_bfe_u32 v65, v64, 6, 2
v_lshlrev_b32 v65, 1, v65
v_xor_b32 v64, v64, v65
v_lshlrev_b32 v64, 1, v64
v_add_u32 v78, s57, v64
s_cmp_eq_u32 s82, 0
s_cselect_b32 s61, 64, 16
v_cmp_gt_u32 vcc, s61, v1
v_mov_b32 v65, s60
s_nop 0
v_cndmask_b32 v78, v65, v78, vcc
v_cmp_le_u32 vcc, 3, v1
v_mov_b32 v64, 4352
s_nop 0
v_cndmask_b32 v66, 0, v64, vcc
v_add_u32 v66, 89600, v66
v_mov_b32 v64, 16592
v_cndmask_b32 v69, 0, v64, vcc
v_lshlrev_b32 v64, 4, v1
v_add_u32 v69, v69, v64
v_add_u32 v69, 4096, v69
v_cmp_eq_u32 vcc, 0, v1
v_cmp_eq_u32 s[70:71], 3, v1
s_or_b64 vcc, vcc, s[70:71]
v_add_u32 v64, 8, v66
v_cndmask_b32 v70, v66, v64, vcc
v_add_u32 v64, 6, v66
v_cndmask_b32 v79, v66, v64, vcc
v_add_u32 v64, 4, v66
v_cndmask_b32 v80, v66, v64, vcc
v_add_u32 v64, 2, v66
v_cndmask_b32 v81, v66, v64, vcc
v_and_b32 v64, 3, v1
v_mul_u32_u24 v82, 4160, v64
v_lshrrev_b32 v65, 4, v1
v_lshlrev_b32 v65, 4, v65
v_sub_u32 v82, v82, v65
v_and_b32 v64, 15, v1
v_lshrrev_b32 v66, 2, v64
v_lshlrev_b32 v66, 3, v66
v_sub_u32 v82, v82, v66
s_mul_i32 s57, s81, 16640
s_lshl_b32 s60, s82, 8
s_sub_u32 s57, s57, s60
s_add_u32 s57, s57, 336
v_add_u32 v82, s57, v82
v_lshlrev_b32 v83, 5, v64
v_sub_u32 v83, v83, v65
s_mul_i32 s57, s81, 4608
s_sub_u32 s57, s57, s60
s_add_u32 s57, s57, 43856
v_add_u32 v83, s57, v83
v_lshlrev_b32 v84, 5, v64
v_lshrrev_b32 v65, 1, v65
v_add_u32 v84, v84, v65
s_add_u32 s90, s88, 1
s_and_b32 s90, s90, 7
s_add_u32 m0, s69, 32768
s_mul_i32 s91, s90, 229376
s_lshl_b32 s90, s90, 7
s_add_u32 s90, s90, s76
s_add_u32 s91, s91, s77
buffer_load_dwordx4 v8, s[36:39], s90 offen offset:0 lds
buffer_load_dwordx4 v9, s[36:39], s90 offen offset:1024 lds
buffer_load_dwordx4 v10, s[36:39], s90 offen offset:2048 lds
buffer_load_dwordx4 v11, s[36:39], s90 offen offset:3072 lds
s_add_u32 m0, s69, 49152
s_nop 0
buffer_load_dwordx4 v12, s[40:43], s91 offen offset:0 lds
buffer_load_dwordx4 v13, s[40:43], s91 offen offset:1024 lds
buffer_load_dwordx4 v14, s[40:43], s91 offen offset:2048 lds
buffer_load_dwordx4 v15, s[40:43], s91 offen offset:3072 lds
s_waitcnt vmcnt(16)
s_mov_b32 s94, 0x3f803f80
v_dot2_f32_bf16 v64, v20, s94, 0
v_dot2_f32_bf16 v66, v20, v20, 0
v_dot2_f32_bf16 v65, v24, s94, 0
v_dot2_f32_bf16 v85, v24, v24, 0
v_dot2_f32_bf16 v64, v21, s94, v64
v_dot2_f32_bf16 v66, v21, v21, v66
v_dot2_f32_bf16 v65, v25, s94, v65
v_dot2_f32_bf16 v85, v25, v25, v85
v_dot2_f32_bf16 v64, v22, s94, v64
v_dot2_f32_bf16 v66, v22, v22, v66
v_dot2_f32_bf16 v65, v26, s94, v65
v_dot2_f32_bf16 v85, v26, v26, v85
v_dot2_f32_bf16 v64, v23, s94, v64
v_dot2_f32_bf16 v66, v23, v23, v66
v_dot2_f32_bf16 v65, v27, s94, v65
v_dot2_f32_bf16 v85, v27, v27, v85
v_add_f32_dpp v64, v64, v64 row_shr:1 row_mask:0xf bank_mask:0xf bound_ctrl:0
v_add_f32_dpp v66, v66, v66 row_shr:1 row_mask:0xf bank_mask:0xf bound_ctrl:0
v_add_f32_dpp v65, v65, v65 row_shr:1 row_mask:0xf bank_mask:0xf bound_ctrl:0
s_add_u32 s90, s88, 2
s_and_b32 s90, s90, 7
s_add_u32 m0, s69, 65536
s_mul_i32 s91, s90, 229376
s_lshl_b32 s90, s90, 7
s_add_u32 s90, s90, s76
s_add_u32 s91, s91, s77
buffer_load_dwordx4 v8, s[36:39], s90 offen offset:0 lds
v_add_f32_dpp v85, v85, v85 row_shr:1 row_mask:0xf bank_mask:0xf bound_ctrl:0
v_add_f32_dpp v64, v64, v64 row_shr:2 row_mask:0xf bank_mask:0xf bound_ctrl:0
v_add_f32_dpp v66, v66, v66 row_shr:2 row_mask:0xf bank_mask:0xf bound_ctrl:0
v_add_f32_dpp v65, v65, v65 row_shr:2 row_mask:0xf bank_mask:0xf bound_ctrl:0
v_add_f32_dpp v85, v85, v85 row_shr:2 row_mask:0xf bank_mask:0xf bound_ctrl:0
v_add_f32_dpp v64, v64, v64 row_shr:4 row_mask:0xf bank_mask:0xf bound_ctrl:0
v_add_f32_dpp v66, v66, v66 row_shr:4 row_mask:0xf bank_mask:0xf bound_ctrl:0
v_add_f32_dpp v65, v65, v65 row_shr:4 row_mask:0xf bank_mask:0xf bound_ctrl:0
v_add_f32_dpp v85, v85, v85 row_shr:4 row_mask:0xf bank_mask:0xf bound_ctrl:0
v_add_f32_dpp v64, v64, v64 row_shr:8 row_mask:0xf bank_mask:0xf bound_ctrl:0
v_add_f32_dpp v66, v66, v66 row_shr:8 row_mask:0xf bank_mask:0xf bound_ctrl:0
v_add_f32_dpp v65, v65, v65 row_shr:8 row_mask:0xf bank_mask:0xf bound_ctrl:0
v_add_f32_dpp v85, v85, v85 row_shr:8 row_mask:0xf bank_mask:0xf bound_ctrl:0
v_add_f32_dpp v64, v64, v64 row_bcast:15 row_mask:0xa bank_mask:0xf
v_add_f32_dpp v66, v66, v66 row_bcast:15 row_mask:0xa bank_mask:0xf
v_add_f32_dpp v65, v65, v65 row_bcast:15 row_mask:0xa bank_mask:0xf
v_add_f32_dpp v85, v85, v85 row_bcast:15 row_mask:0xa bank_mask:0xf
v_add_f32_dpp v64, v64, v64 row_bcast:31 row_mask:0xc bank_mask:0xf
v_add_f32_dpp v66, v66, v66 row_bcast:31 row_mask:0xc bank_mask:0xf
v_add_f32_dpp v65, v65, v65 row_bcast:31 row_mask:0xc bank_mask:0xf
buffer_load_dwordx4 v9, s[36:39], s90 offen offset:1024 lds
v_add_f32_dpp v85, v85, v85 row_bcast:31 row_mask:0xc bank_mask:0xf
v_readlane_b32 s95, v64, 63
v_readlane_b32 s96, v66, 63
v_readlane_b32 s97, v65, 63
v_readlane_b32 s98, v85, 63
v_mov_b32 v196, s95
v_mov_b32 v197, s97
v_mul_f32 v196, 0x3b000000, v196
v_mul_f32 v197, 0x3b000000, v197
v_mov_b32 v198, s96
v_mov_b32 v199, s98
v_mul_f32 v198, 0x3b000000, v198
v_mul_f32 v199, 0x3b000000, v199
v_fma_f32 v198, -v196, v196, v198
v_fma_f32 v199, -v197, v197, v199
v_max_f32 v198, 0, v198
v_max_f32 v199, 0, v199
v_cvt_pk_bf16_f32 v196, v196, v196
v_cvt_pk_bf16_f32 v197, v197, v197
v_and_b32 v86, 0xffff0000, v196
buffer_load_dwordx4 v10, s[36:39], s90 offen offset:2048 lds
v_and_b32 v87, 0xffff0000, v197
v_xor_b32 v188, 0x80008000, v196
v_xor_b32 v192, 0x80008000, v197
v_cvt_pk_bf16_f32 v198, v198, v198
v_cvt_pk_bf16_f32 v199, v199, v199
v_and_b32 v198, 0xffff0000, v198
v_and_b32 v199, 0xffff0000, v199
v_add_f32 v198, 0x3727c5ac, v198
v_add_f32 v199, 0x3727c5ac, v199
v_cvt_pk_bf16_f32 v198, v198, v198
v_cvt_pk_bf16_f32 v199, v199, v199
v_and_b32 v198, 0xffff0000, v198
v_and_b32 v199, 0xffff0000, v199
v_sqrt_f32 v198, v198
v_sqrt_f32 v199, v199
v_cvt_pk_bf16_f32 v198, v198, v198
v_cvt_pk_bf16_f32 v199, v199, v199
v_and_b32 v198, 0xffff0000, v198
v_and_b32 v199, 0xffff0000, v199
v_rcp_f32 v189, v198
buffer_load_dwordx4 v11, s[36:39], s90 offen offset:3072 lds
v_rcp_f32 v193, v199
v_mov_b32 v232, 0
global_load_dwordx2 v[222:223], v232, s[30:31] sc1
v_lshlrev_b32 v201, 16, v20
v_lshlrev_b32 v209, 16, v24
v_and_b32 v202, 0xffff0000, v20
v_and_b32 v210, 0xffff0000, v24
v_sub_f32 v201, v201, v86
v_sub_f32 v209, v209, v87
v_sub_f32 v202, v202, v86
v_sub_f32 v210, v210, v87
v_cvt_pk_bf16_f32 v217, v201, v202
v_cvt_pk_bf16_f32 v218, v209, v210
v_lshlrev_b32 v201, 16, v217
v_lshlrev_b32 v209, 16, v218
v_and_b32 v202, 0xffff0000, v217
v_and_b32 v210, 0xffff0000, v218
v_mul_f32 v201, v201, v189
v_mul_f32 v209, v209, v193
v_mul_f32 v202, v202, v189
v_mul_f32 v210, v210, v193
v_lshlrev_b32 v203, 16, v21
s_add_u32 m0, s69, 81920
s_nop 0
buffer_load_dwordx4 v12, s[40:43], s91 offen offset:0 lds
v_lshlrev_b32 v211, 16, v25
v_and_b32 v204, 0xffff0000, v21
v_and_b32 v212, 0xffff0000, v25
v_sub_f32 v203, v203, v86
v_sub_f32 v211, v211, v87
v_sub_f32 v204, v204, v86
v_sub_f32 v212, v212, v87
v_cvt_pk_bf16_f32 v217, v203, v204
v_cvt_pk_bf16_f32 v218, v211, v212
v_lshlrev_b32 v203, 16, v217
v_lshlrev_b32 v211, 16, v218
v_and_b32 v204, 0xffff0000, v217
v_and_b32 v212, 0xffff0000, v218
v_mul_f32 v203, v203, v189
v_mul_f32 v211, v211, v193
v_mul_f32 v204, v204, v189
v_mul_f32 v212, v212, v193
v_lshlrev_b32 v205, 16, v22
v_lshlrev_b32 v213, 16, v26
v_and_b32 v206, 0xffff0000, v22
buffer_load_dwordx4 v13, s[40:43], s91 offen offset:1024 lds
v_and_b32 v214, 0xffff0000, v26
v_sub_f32 v205, v205, v86
v_sub_f32 v213, v213, v87
v_sub_f32 v206, v206, v86
v_sub_f32 v214, v214, v87
v_cvt_pk_bf16_f32 v217, v205, v206
v_cvt_pk_bf16_f32 v218, v213, v214
v_lshlrev_b32 v205, 16, v217
v_lshlrev_b32 v213, 16, v218
v_and_b32 v206, 0xffff0000, v217
v_and_b32 v214, 0xffff0000, v218
v_mul_f32 v205, v205, v189
v_mul_f32 v213, v213, v193
v_mul_f32 v206, v206, v189
v_mul_f32 v214, v214, v193
v_lshlrev_b32 v207, 16, v23
v_lshlrev_b32 v215, 16, v27
v_and_b32 v208, 0xffff0000, v23
v_and_b32 v216, 0xffff0000, v27
v_sub_f32 v207, v207, v86
buffer_load_dwordx4 v14, s[40:43], s91 offen offset:2048 lds
v_sub_f32 v215, v215, v87
v_sub_f32 v208, v208, v86
v_sub_f32 v216, v216, v87
v_cvt_pk_bf16_f32 v217, v207, v208
v_cvt_pk_bf16_f32 v218, v215, v216
v_lshlrev_b32 v207, 16, v217
v_lshlrev_b32 v215, 16, v218
v_and_b32 v208, 0xffff0000, v217
v_and_b32 v216, 0xffff0000, v218
v_mul_f32 v207, v207, v189
v_mul_f32 v215, v215, v193
v_mul_f32 v208, v208, v189
v_mul_f32 v216, v216, v193
s_lshl_b32 s95, s54, 2
s_add_u32 s95, s95, 131072
v_add_u32 v219, s95, v2
v_cvt_pk_bf16_f32 v201, v201, v209
ds_write_b32 v219, v201 offset:0
v_cvt_pk_bf16_f32 v202, v202, v210
ds_write_b32 v219, v202 offset:1040
buffer_load_dwordx4 v15, s[40:43], s91 offen offset:3072 lds
v_cvt_pk_bf16_f32 v203, v203, v211
ds_write_b32 v219, v203 offset:2080
v_cvt_pk_bf16_f32 v204, v204, v212
ds_write_b32 v219, v204 offset:3120
v_cvt_pk_bf16_f32 v205, v205, v213
ds_write_b32 v219, v205 offset:4160
v_cvt_pk_bf16_f32 v206, v206, v214
ds_write_b32 v219, v206 offset:5200
v_cvt_pk_bf16_f32 v207, v207, v215
ds_write_b32 v219, v207 offset:6240
v_cvt_pk_bf16_f32 v208, v208, v216
ds_write_b32 v219, v208 offset:7280
v_and_b32 v220, 7, v0
v_mul_u32_u24 v220, 65, v220
v_lshrrev_b32 v221, 3, v0
v_add_u32 v220, v220, v221
v_lshlrev_b32 v220, 4, v220
v_add_u32 v220, 131072, v220
v_lshlrev_b32 v221, 4, v0
s_lshl_b32 s96, s55, 13
s_add_u32 s90, s88, 3
s_and_b32 s90, s90, 7
s_add_u32 m0, s69, 98304
s_mul_i32 s91, s90, 229376
s_lshl_b32 s90, s90, 7
s_add_u32 s90, s90, s76
s_add_u32 s91, s91, s77
buffer_load_dwordx4 v8, s[36:39], s90 offen offset:0 lds
s_waitcnt lgkmcnt(0)
s_waitcnt vmcnt(18)
s_barrier
ds_read_b64_tr_b16 v[88:89], v34 offset:0
ds_read_b64_tr_b16 v[90:91], v34 offset:1024
ds_read_b128 v[104:107], v18 offset:0
ds_read_b128 v[108:111], v18 offset:4096
ds_read_b64_tr_b16 v[92:93], v35 offset:0
ds_read_b64_tr_b16 v[94:95], v35 offset:1024
s_waitcnt lgkmcnt(2)
v_mfma_f32_32x32x16_bf16 v[120:135], v[88:91], v[104:107], 0
ds_read_b64_tr_b16 v[96:97], v34 offset:4096
ds_read_b64_tr_b16 v[98:99], v34 offset:5120
buffer_load_dwordx4 v9, s[36:39], s90 offen offset:1024 lds
ds_read_b128 v[224:227], v220
ds_read_b128 v[228:231], v220 offset:512
v_add_u32 v220, 4096, v221
v_mfma_f32_32x32x16_bf16 v[136:151], v[88:91], v[108:111], 0
ds_read_b128 v[112:115], v19 offset:0
ds_read_b128 v[116:119], v19 offset:4096
s_waitcnt lgkmcnt(2)
buffer_store_dwordx4 v[224:227], v221, s[48:51], s96 offen sc1
buffer_store_dwordx4 v[228:231], v220, s[48:51], s96 offen sc1
v_mfma_f32_32x32x16_bf16 v[152:167], v[92:95], v[104:107], 0
ds_read_b64_tr_b16 v[100:101], v35 offset:4096
ds_read_b64_tr_b16 v[102:103], v35 offset:5120
buffer_load_dwordx4 v10, s[36:39], s90 offen offset:2048 lds
v_mfma_f32_32x32x16_bf16 v[168:183], v[92:95], v[108:111], 0
v_mfma_f32_16x16x32_bf16 v[184:187], v[44:47], v[88:91], 0
s_waitcnt lgkmcnt(2)
v_mfma_f32_32x32x16_bf16 v[120:135], v[96:99], v[112:115], v[120:135]
ds_read_b64_tr_b16 v[88:89], v34 offset:8192
ds_read_b64_tr_b16 v[90:91], v34 offset:9216
buffer_load_dwordx4 v11, s[36:39], s90 offen offset:3072 lds
v_mfma_f32_32x32x16_bf16 v[136:151], v[96:99], v[116:119], v[136:151]
ds_read_b128 v[104:107], v28 offset:0
ds_read_b128 v[108:111], v28 offset:4096
s_waitcnt lgkmcnt(4)
v_mfma_f32_32x32x16_bf16 v[152:167], v[100:103], v[112:115], v[152:167]
ds_read_b64_tr_b16 v[92:93], v35 offset:8192
ds_read_b64_tr_b16 v[94:95], v35 offset:9216
s_add_u32 m0, s69, 114688
s_nop 0
buffer_load_dwordx4 v12, s[40:43], s91 offen offset:0 lds
v_mfma_f32_32x32x16_bf16 v[168:183], v[100:103], v[116:119], v[168:183]
v_mfma_f32_16x16x32_bf16 v[184:187], v[44:47], v[96:99], v[184:187]
s_waitcnt vmcnt(11)
v_readfirstlane_b32 s58, v222
v_readfirstlane_b32 s59, v223
s_cmp_eq_u32 s58, 0
s_cbranch_scc1 L_np_4
L_nd_5:
s_waitcnt lgkmcnt(2)
v_mfma_f32_32x32x16_bf16 v[120:135], v[88:91], v[104:107], v[120:135]
ds_read_b64_tr_b16 v[96:97], v34 offset:12288
ds_read_b64_tr_b16 v[98:99], v34 offset:13312
buffer_load_dwordx4 v13, s[40:43], s91 offen offset:1024 lds
v_mov_b32 v190, s58
v_mov_b32 v191, s59
v_mfma_f32_32x32x16_bf16 v[136:151], v[88:91], v[108:111], v[136:151]
ds_read_b128 v[112:115], v29 offset:0
ds_read_b128 v[116:119], v29 offset:4096
v_mov_b32 v194, s58
v_mov_b32 v195, s59
s_lshl_b32 s94, s93, 4
s_waitcnt lgkmcnt(4)
v_mfma_f32_32x32x16_bf16 v[152:167], v[92:95], v[104:107], v[152:167]
ds_read_b64_tr_b16 v[100:101], v35 offset:12288
ds_read_b64_tr_b16 v[102:103], v35 offset:13312
buffer_load_dwordx4 v14, s[40:43], s91 offen offset:2048 lds
s_add_u32 s94, s94, 2097152
v_lshlrev_b32 v200, 28, v1
v_mfma_f32_32x32x16_bf16 v[168:183], v[92:95], v[108:111], v[168:183]
buffer_store_dwordx4 v[188:191], v200, s[48:51], s94 offen offset:0 sc1
buffer_store_dwordx4 v[192:195], v200, s[48:51], s94 offen offset:16 sc1
v_mfma_f32_16x16x32_bf16 v[184:187], v[44:47], v[88:91], v[184:187]
s_waitcnt lgkmcnt(0)
s_barrier
v_mfma_f32_32x32x16_bf16 v[120:135], v[96:99], v[112:115], v[120:135]
ds_read_b64_tr_b16 v[88:89], v34 offset:32768
ds_read_b64_tr_b16 v[90:91], v34 offset:33792
buffer_load_dwordx4 v15, s[40:43], s91 offen offset:3072 lds
v_mfma_f32_32x32x16_bf16 v[136:151], v[96:99], v[116:119], v[136:151]
ds_read_b128 v[104:107], v18 offset:32768
ds_read_b128 v[108:111], v18 offset:36864
v_mfma_f32_32x32x16_bf16 v[152:167], v[100:103], v[112:115], v[152:167]
ds_read_b64_tr_b16 v[92:93], v35 offset:32768
ds_read_b64_tr_b16 v[94:95], v35 offset:33792
v_mov_b32 v232, -1
v_mov_b32 v233, -1
v_mov_b32 v234, -1
v_mov_b32 v235, -1
v_lshlrev_b32 v222, 4, v0
s_lshl_b32 s57, s80, 12
s_add_u32 s57, s57, 3145728
s_add_u32 s60, s57, 4096
buffer_store_dwordx4 v[232:235], v222, s[48:51], s57 offen sc1
buffer_store_dwordx4 v[232:235], v222, s[48:51], s60 offen sc1
v_mfma_f32_32x32x16_bf16 v[168:183], v[100:103], v[116:119], v[168:183]
s_add_u32 s90, s88, 4
s_and_b32 s90, s90, 7
s_add_u32 m0, s69, 0
s_mul_i32 s91, s90, 229376
s_lshl_b32 s90, s90, 7
s_add_u32 s90, s90, s76
s_add_u32 s91, s91, s77
buffer_load_dwordx4 v8, s[36:39], s90 offen offset:0 lds
v_mfma_f32_16x16x32_bf16 v[184:187], v[44:47], v[96:99], v[184:187]
s_waitcnt lgkmcnt(2)
v_mfma_f32_32x32x16_bf16 v[120:135], v[88:91], v[104:107], v[120:135]
ds_read_b64_tr_b16 v[96:97], v34 offset:36864
ds_read_b64_tr_b16 v[98:99], v34 offset:37888
buffer_load_dwordx4 v9, s[36:39], s90 offen offset:1024 lds
v_mfma_f32_32x32x16_bf16 v[136:151], v[88:91], v[108:111], v[136:151]
ds_read_b128 v[112:115], v19 offset:32768
ds_read_b128 v[116:119], v19 offset:36864
s_waitcnt lgkmcnt(4)
v_mfma_f32_32x32x16_bf16 v[152:167], v[92:95], v[104:107], v[152:167]
ds_read_b64_tr_b16 v[100:101], v35 offset:36864
ds_read_b64_tr_b16 v[102:103], v35 offset:37888
buffer_load_dwordx4 v10, s[36:39], s90 offen offset:2048 lds
v_mfma_f32_32x32x16_bf16 v[168:183], v[92:95], v[108:111], v[168:183]
v_mfma_f32_16x16x32_bf16 v[184:187], v[44:47], v[88:91], v[184:187]
s_waitcnt lgkmcnt(2)
v_mfma_f32_32x32x16_bf16 v[120:135], v[96:99], v[112:115], v[120:135]
ds_read_b64_tr_b16 v[88:89], v34 offset:40960
ds_read_b64_tr_b16 v[90:91], v34 offset:41984
buffer_load_dwordx4 v11, s[36:39], s90 offen offset:3072 lds
v_mfma_f32_32x32x16_bf16 v[136:151], v[96:99], v[116:119], v[136:151]
ds_read_b128 v[104:107], v28 offset:32768
ds_read_b128 v[108:111], v28 offset:36864
s_waitcnt lgkmcnt(4)
v_mfma_f32_32x32x16_bf16 v[152:167], v[100:103], v[112:115], v[152:167]
ds_read_b64_tr_b16 v[92:93], v35 offset:40960
ds_read_b64_tr_b16 v[94:95], v35 offset:41984
s_add_u32 m0, s69, 16384
s_nop 0
buffer_load_dwordx4 v12, s[40:43], s91 offen offset:0 lds
v_mfma_f32_32x32x16_bf16 v[168:183], v[100:103], v[116:119], v[168:183]
v_mfma_f32_16x16x32_bf16 v[184:187], v[44:47], v[96:99], v[184:187]
s_waitcnt lgkmcnt(2)
v_mfma_f32_32x32x16_bf16 v[120:135], v[88:91], v[104:107], v[120:135]
ds_read_b64_tr_b16 v[96:97], v34 offset:45056
ds_read_b64_tr_b16 v[98:99], v34 offset:46080
buffer_load_dwordx4 v13, s[40:43], s91 offen offset:1024 lds
v_mfma_f32_32x32x16_bf16 v[136:151], v[88:91], v[108:111], v[136:151]
ds_read_b128 v[112:115], v29 offset:32768
ds_read_b128 v[116:119], v29 offset:36864
s_waitcnt lgkmcnt(4)
v_mfma_f32_32x32x16_bf16 v[152:167], v[92:95], v[104:107], v[152:167]
ds_read_b64_tr_b16 v[100:101], v35 offset:45056
ds_read_b64_tr_b16 v[102:103], v35 offset:46080
buffer_load_dwordx4 v14, s[40:43], s91 offen offset:2048 lds
v_mfma_f32_32x32x16_bf16 v[168:183], v[92:95], v[108:111], v[168:183]
v_mfma_f32_16x16x32_bf16 v[184:187], v[44:47], v[88:91], v[184:187]
s_waitcnt lgkmcnt(0)
s_waitcnt vmcnt(21)
s_barrier
v_mfma_f32_32x32x16_bf16 v[120:135], v[96:99], v[112:115], v[120:135]
ds_read_b64_tr_b16 v[88:89], v36 offset:0
ds_read_b64_tr_b16 v[90:91], v36 offset:1024
buffer_load_dwordx4 v15, s[40:43], s91 offen offset:3072 lds
v_mfma_f32_32x32x16_bf16 v[136:151], v[96:99], v[116:119], v[136:151]
ds_read_b128 v[104:107], v30 offset:0
ds_read_b128 v[108:111], v30 offset:4096
v_mfma_f32_32x32x16_bf16 v[152:167], v[100:103], v[112:115], v[152:167]
ds_read_b64_tr_b16 v[92:93], v37 offset:0
ds_read_b64_tr_b16 v[94:95], v37 offset:1024
s_add_u32 s90, s88, 5
s_and_b32 s90, s90, 7
s_add_u32 m0, s69, 32768
s_mul_i32 s91, s90, 229376
s_lshl_b32 s90, s90, 7
s_add_u32 s90, s90, s76
s_add_u32 s91, s91, s77
buffer_load_dwordx4 v8, s[36:39], s90 offen offset:0 lds
v_mfma_f32_32x32x16_bf16 v[168:183], v[100:103], v[116:119], v[168:183]
buffer_load_dwordx4 v9, s[36:39], s90 offen offset:1024 lds
v_mfma_f32_16x16x32_bf16 v[184:187], v[44:47], v[96:99], v[184:187]
s_waitcnt lgkmcnt(2)
v_mfma_f32_32x32x16_bf16 v[120:135], v[88:91], v[104:107], v[120:135]
ds_read_b64_tr_b16 v[96:97], v36 offset:4096
ds_read_b64_tr_b16 v[98:99], v36 offset:5120
buffer_load_dwordx4 v10, s[36:39], s90 offen offset:2048 lds
v_mfma_f32_32x32x16_bf16 v[136:151], v[88:91], v[108:111], v[136:151]
ds_read_b128 v[112:115], v31 offset:0
ds_read_b128 v[116:119], v31 offset:4096
s_waitcnt lgkmcnt(4)
v_mfma_f32_32x32x16_bf16 v[152:167], v[92:95], v[104:107], v[152:167]
ds_read_b64_tr_b16 v[100:101], v37 offset:4096
ds_read_b64_tr_b16 v[102:103], v37 offset:5120
buffer_load_dwordx4 v11, s[36:39], s90 offen offset:3072 lds
v_mfma_f32_32x32x16_bf16 v[168:183], v[92:95], v[108:111], v[168:183]
v_mfma_f32_16x16x32_bf16 v[184:187], v[44:47], v[88:91], v[184:187]
s_waitcnt lgkmcnt(2)
v_mfma_f32_32x32x16_bf16 v[120:135], v[96:99], v[112:115], v[120:135]
ds_read_b64_tr_b16 v[88:89], v36 offset:8192
ds_read_b64_tr_b16 v[90:91], v36 offset:9216
s_add_u32 m0, s69, 49152
s_nop 0
buffer_load_dwordx4 v12, s[40:43], s91 offen offset:0 lds
v_mfma_f32_32x32x16_bf16 v[136:151], v[96:99], v[116:119], v[136:151]
ds_read_b128 v[104:107], v32 offset:0
ds_read_b128 v[108:111], v32 offset:4096
s_waitcnt lgkmcnt(4)
v_mfma_f32_32x32x16_bf16 v[152:167], v[100:103], v[112:115], v[152:167]
ds_read_b64_tr_b16 v[92:93], v37 offset:8192
ds_read_b64_tr_b16 v[94:95], v37 offset:9216
buffer_load_dwordx4 v13, s[40:43], s91 offen offset:1024 lds
v_mfma_f32_32x32x16_bf16 v[168:183], v[100:103], v[116:119], v[168:183]
v_mfma_f32_16x16x32_bf16 v[184:187], v[44:47], v[96:99], v[184:187]
s_waitcnt lgkmcnt(2)
v_mfma_f32_32x32x16_bf16 v[120:135], v[88:91], v[104:107], v[120:135]
ds_read_b64_tr_b16 v[96:97], v36 offset:12288
ds_read_b64_tr_b16 v[98:99], v36 offset:13312
buffer_load_dwordx4 v14, s[40:43], s91 offen offset:2048 lds
v_mfma_f32_32x32x16_bf16 v[136:151], v[88:91], v[108:111], v[136:151]
ds_read_b128 v[112:115], v33 offset:0
ds_read_b128 v[116:119], v33 offset:4096
s_waitcnt lgkmcnt(4)
v_mfma_f32_32x32x16_bf16 v[152:167], v[92:95], v[104:107], v[152:167]
ds_read_b64_tr_b16 v[100:101], v37 offset:12288
ds_read_b64_tr_b16 v[102:103], v37 offset:13312
buffer_load_dwordx4 v15, s[40:43], s91 offen offset:3072 lds
v_mfma_f32_32x32x16_bf16 v[168:183], v[92:95], v[108:111], v[168:183]
v_mfma_f32_16x16x32_bf16 v[184:187], v[44:47], v[88:91], v[184:187]
s_waitcnt lgkmcnt(0)
s_waitcnt vmcnt(18)
s_barrier
v_mfma_f32_32x32x16_bf16 v[120:135], v[96:99], v[112:115], v[120:135]
ds_read_b64_tr_b16 v[88:89], v36 offset:32768
ds_read_b64_tr_b16 v[90:91], v36 offset:33792
s_add_u32 s90, s88, 6
s_and_b32 s90, s90, 7
s_add_u32 m0, s69, 65536
s_mul_i32 s91, s90, 229376
s_lshl_b32 s90, s90, 7
s_add_u32 s90, s90, s76
s_add_u32 s91, s91, s77
buffer_load_dwordx4 v8, s[36:39], s90 offen offset:0 lds
v_mfma_f32_32x32x16_bf16 v[136:151], v[96:99], v[116:119], v[136:151]
ds_read_b128 v[104:107], v30 offset:32768
ds_read_b128 v[108:111], v30 offset:36864
v_mfma_f32_32x32x16_bf16 v[152:167], v[100:103], v[112:115], v[152:167]
ds_read_b64_tr_b16 v[92:93], v37 offset:32768
ds_read_b64_tr_b16 v[94:95], v37 offset:33792
buffer_load_dwordx4 v9, s[36:39], s90 offen offset:1024 lds
v_mfma_f32_32x32x16_bf16 v[168:183], v[100:103], v[116:119], v[168:183]
v_mfma_f32_16x16x32_bf16 v[184:187], v[44:47], v[96:99], v[184:187]
s_waitcnt lgkmcnt(2)
v_mfma_f32_32x32x16_bf16 v[120:135], v[88:91], v[104:107], v[120:135]
ds_read_b64_tr_b16 v[96:97], v36 offset:36864
ds_read_b64_tr_b16 v[98:99], v36 offset:37888
buffer_load_dwordx4 v10, s[36:39], s90 offen offset:2048 lds
v_mfma_f32_32x32x16_bf16 v[136:151], v[88:91], v[108:111], v[136:151]
ds_read_b128 v[112:115], v31 offset:32768
ds_read_b128 v[116:119], v31 offset:36864
s_waitcnt lgkmcnt(4)
v_mfma_f32_32x32x16_bf16 v[152:167], v[92:95], v[104:107], v[152:167]
ds_read_b64_tr_b16 v[100:101], v37 offset:36864
ds_read_b64_tr_b16 v[102:103], v37 offset:37888
buffer_load_dwordx4 v11, s[36:39], s90 offen offset:3072 lds
v_mfma_f32_32x32x16_bf16 v[168:183], v[92:95], v[108:111], v[168:183]
v_mfma_f32_16x16x32_bf16 v[184:187], v[44:47], v[88:91], v[184:187]
s_waitcnt lgkmcnt(2)
v_mfma_f32_32x32x16_bf16 v[120:135], v[96:99], v[112:115], v[120:135]
ds_read_b64_tr_b16 v[88:89], v36 offset:40960
ds_read_b64_tr_b16 v[90:91], v36 offset:41984
s_add_u32 m0, s69, 81920
s_nop 0
buffer_load_dwordx4 v12, s[40:43], s91 offen offset:0 lds
v_mfma_f32_32x32x16_bf16 v[136:151], v[96:99], v[116:119], v[136:151]
ds_read_b128 v[104:107], v32 offset:32768
ds_read_b128 v[108:111], v32 offset:36864
s_waitcnt lgkmcnt(4)
v_mfma_f32_32x32x16_bf16 v[152:167], v[100:103], v[112:115], v[152:167]
ds_read_b64_tr_b16 v[92:93], v37 offset:40960
ds_read_b64_tr_b16 v[94:95], v37 offset:41984
buffer_load_dwordx4 v13, s[40:43], s91 offen offset:1024 lds
v_mfma_f32_32x32x16_bf16 v[168:183], v[100:103], v[116:119], v[168:183]
v_mfma_f32_16x16x32_bf16 v[184:187], v[44:47], v[96:99], v[184:187]
s_waitcnt lgkmcnt(2)
v_mfma_f32_32x32x16_bf16 v[120:135], v[88:91], v[104:107], v[120:135]
ds_read_b64_tr_b16 v[96:97], v36 offset:45056
ds_read_b64_tr_b16 v[98:99], v36 offset:46080
buffer_load_dwordx4 v14, s[40:43], s91 offen offset:2048 lds
v_mfma_f32_32x32x16_bf16 v[136:151], v[88:91], v[108:111], v[136:151]
ds_read_b128 v[112:115], v33 offset:32768
ds_read_b128 v[116:119], v33 offset:36864
s_waitcnt lgkmcnt(4)
v_mfma_f32_32x32x16_bf16 v[152:167], v[92:95], v[104:107], v[152:167]
ds_read_b64_tr_b16 v[100:101], v37 offset:45056
ds_read_b64_tr_b16 v[102:103], v37 offset:46080
buffer_load_dwordx4 v15, s[40:43], s91 offen offset:3072 lds
v_mfma_f32_32x32x16_bf16 v[168:183], v[92:95], v[108:111], v[168:183]
v_mfma_f32_16x16x32_bf16 v[184:187], v[44:47], v[88:91], v[184:187]
s_waitcnt lgkmcnt(0)
s_waitcnt vmcnt(16)
s_barrier
s_lshl_b32 s60, s55, 3
s_add_u32 s60, s60, 2129920
v_lshlrev_b32 v232, 24, v0
v_mov_b32 v222, s58
v_mov_b32 v223, s59
buffer_store_dwordx2 v[222:223], v232, s[48:51], s60 offen sc1
v_mfma_f32_32x32x16_bf16 v[120:135], v[96:99], v[112:115], v[120:135]
ds_read_b64_tr_b16 v[88:89], v34 offset:0
ds_read_b64_tr_b16 v[90:91], v34 offset:1024
s_add_u32 s90, s88, 7
s_and_b32 s90, s90, 7
s_add_u32 m0, s69, 98304
s_mul_i32 s91, s90, 229376
s_lshl_b32 s90, s90, 7
s_add_u32 s90, s90, s76
s_add_u32 s91, s91, s77
buffer_load_dwordx4 v8, s[36:39], s90 offen offset:0 lds
v_mfma_f32_32x32x16_bf16 v[136:151], v[96:99], v[116:119], v[136:151]
ds_read_b128 v[104:107], v18 offset:0
ds_read_b128 v[108:111], v18 offset:4096
v_mfma_f32_32x32x16_bf16 v[152:167], v[100:103], v[112:115], v[152:167]
ds_read_b64_tr_b16 v[92:93], v35 offset:0
ds_read_b64_tr_b16 v[94:95], v35 offset:1024
buffer_load_dwordx4 v9, s[36:39], s90 offen offset:1024 lds
v_mfma_f32_32x32x16_bf16 v[168:183], v[100:103], v[116:119], v[168:183]
v_mfma_f32_16x16x32_bf16 v[184:187], v[44:47], v[96:99], v[184:187]
s_waitcnt lgkmcnt(2)
v_mfma_f32_32x32x16_bf16 v[120:135], v[88:91], v[104:107], v[120:135]
ds_read_b64_tr_b16 v[96:97], v34 offset:4096
ds_read_b64_tr_b16 v[98:99], v34 offset:5120
buffer_load_dwordx4 v10, s[36:39], s90 offen offset:2048 lds
v_mfma_f32_32x32x16_bf16 v[136:151], v[88:91], v[108:111], v[136:151]
ds_read_b128 v[112:115], v19 offset:0
ds_read_b128 v[116:119], v19 offset:4096
s_waitcnt lgkmcnt(4)
v_mfma_f32_32x32x16_bf16 v[152:167], v[92:95], v[104:107], v[152:167]
ds_read_b64_tr_b16 v[100:101], v35 offset:4096
ds_read_b64_tr_b16 v[102:103], v35 offset:5120
buffer_load_dwordx4 v11, s[36:39], s90 offen offset:3072 lds
v_mfma_f32_32x32x16_bf16 v[168:183], v[92:95], v[108:111], v[168:183]
v_mfma_f32_16x16x32_bf16 v[184:187], v[44:47], v[88:91], v[184:187]
s_waitcnt lgkmcnt(2)
v_mfma_f32_32x32x16_bf16 v[120:135], v[96:99], v[112:115], v[120:135]
ds_read_b64_tr_b16 v[88:89], v34 offset:8192
ds_read_b64_tr_b16 v[90:91], v34 offset:9216
s_add_u32 m0, s69, 114688
s_nop 0
buffer_load_dwordx4 v12, s[40:43], s91 offen offset:0 lds
v_mfma_f32_32x32x16_bf16 v[136:151], v[96:99], v[116:119], v[136:151]
ds_read_b128 v[104:107], v28 offset:0
ds_read_b128 v[108:111], v28 offset:4096
s_waitcnt lgkmcnt(4)
v_mfma_f32_32x32x16_bf16 v[152:167], v[100:103], v[112:115], v[152:167]
ds_read_b64_tr_b16 v[92:93], v35 offset:8192
ds_read_b64_tr_b16 v[94:95], v35 offset:9216
buffer_load_dwordx4 v13, s[40:43], s91 offen offset:1024 lds
v_mfma_f32_32x32x16_bf16 v[168:183], v[100:103], v[116:119], v[168:183]
v_mfma_f32_16x16x32_bf16 v[184:187], v[44:47], v[96:99], v[184:187]
s_waitcnt lgkmcnt(2)
v_mfma_f32_32x32x16_bf16 v[120:135], v[88:91], v[104:107], v[120:135]
ds_read_b64_tr_b16 v[96:97], v34 offset:12288
ds_read_b64_tr_b16 v[98:99], v34 offset:13312
buffer_load_dwordx4 v14, s[40:43], s91 offen offset:2048 lds
v_mfma_f32_32x32x16_bf16 v[136:151], v[88:91], v[108:111], v[136:151]
ds_read_b128 v[112:115], v29 offset:0
ds_read_b128 v[116:119], v29 offset:4096
s_waitcnt lgkmcnt(4)
v_mfma_f32_32x32x16_bf16 v[152:167], v[92:95], v[104:107], v[152:167]
ds_read_b64_tr_b16 v[100:101], v35 offset:12288
ds_read_b64_tr_b16 v[102:103], v35 offset:13312
buffer_load_dwordx4 v15, s[40:43], s91 offen offset:3072 lds
v_mfma_f32_32x32x16_bf16 v[168:183], v[92:95], v[108:111], v[168:183]
v_mfma_f32_16x16x32_bf16 v[184:187], v[44:47], v[88:91], v[184:187]
s_waitcnt lgkmcnt(0)
s_waitcnt vmcnt(17)
s_barrier
v_mfma_f32_32x32x16_bf16 v[120:135], v[96:99], v[112:115], v[120:135]
ds_read_b64_tr_b16 v[88:89], v34 offset:32768
ds_read_b64_tr_b16 v[90:91], v34 offset:33792
s_add_u32 s92, s89, 0
s_sub_u32 s67, s92, 7
s_cmp_ge_u32 s92, 7
s_cselect_b32 s92, s67, s92
s_add_u32 m0, s87, 0
s_lshl_b32 s92, s92, 16
s_add_u32 s92, s92, s86
buffer_load_dwordx4 v54, s[44:47], s92 offen offset:0 lds
v_mfma_f32_32x32x16_bf16 v[136:151], v[96:99], v[116:119], v[136:151]
ds_read_b128 v[104:107], v18 offset:32768
ds_read_b128 v[108:111], v18 offset:36864
v_mfma_f32_32x32x16_bf16 v[152:167], v[100:103], v[112:115], v[152:167]
ds_read_b64_tr_b16 v[92:93], v35 offset:32768
ds_read_b64_tr_b16 v[94:95], v35 offset:33792
buffer_load_dwordx4 v55, s[44:47], s92 offen offset:1024 lds
v_mfma_f32_32x32x16_bf16 v[168:183], v[100:103], v[116:119], v[168:183]
v_mfma_f32_16x16x32_bf16 v[184:187], v[44:47], v[96:99], v[184:187]
s_waitcnt lgkmcnt(2)
v_mfma_f32_32x32x16_bf16 v[120:135], v[88:91], v[104:107], v[120:135]
ds_read_b64_tr_b16 v[96:97], v34 offset:36864
ds_read_b64_tr_b16 v[98:99], v34 offset:37888
buffer_load_dwordx4 v56, s[44:47], s92 offen offset:2048 lds
v_mfma_f32_32x32x16_bf16 v[136:151], v[88:91], v[108:111], v[136:151]
ds_read_b128 v[112:115], v19 offset:32768
ds_read_b128 v[116:119], v19 offset:36864
s_waitcnt lgkmcnt(4)
v_mfma_f32_32x32x16_bf16 v[152:167], v[92:95], v[104:107], v[152:167]
ds_read_b64_tr_b16 v[100:101], v35 offset:36864
ds_read_b64_tr_b16 v[102:103], v35 offset:37888
buffer_load_dwordx4 v57, s[44:47], s92 offen offset:3072 lds
v_mfma_f32_32x32x16_bf16 v[168:183], v[92:95], v[108:111], v[168:183]
v_mfma_f32_16x16x32_bf16 v[184:187], v[44:47], v[88:91], v[184:187]
s_waitcnt lgkmcnt(2)
v_mfma_f32_32x32x16_bf16 v[120:135], v[96:99], v[112:115], v[120:135]
ds_read_b64_tr_b16 v[88:89], v34 offset:40960
ds_read_b64_tr_b16 v[90:91], v34 offset:41984
s_add_u32 m0, s87, 4096
s_add_u32 s92, s92, 32768
buffer_load_dwordx4 v54, s[44:47], s92 offen offset:0 lds
v_mfma_f32_32x32x16_bf16 v[136:151], v[96:99], v[116:119], v[136:151]
ds_read_b128 v[104:107], v28 offset:32768
ds_read_b128 v[108:111], v28 offset:36864
s_waitcnt lgkmcnt(4)
v_mfma_f32_32x32x16_bf16 v[152:167], v[100:103], v[112:115], v[152:167]
ds_read_b64_tr_b16 v[92:93], v35 offset:40960
ds_read_b64_tr_b16 v[94:95], v35 offset:41984
buffer_load_dwordx4 v55, s[44:47], s92 offen offset:1024 lds
v_mfma_f32_32x32x16_bf16 v[168:183], v[100:103], v[116:119], v[168:183]
v_mfma_f32_16x16x32_bf16 v[184:187], v[44:47], v[96:99], v[184:187]
s_waitcnt lgkmcnt(2)
v_mfma_f32_32x32x16_bf16 v[120:135], v[88:91], v[104:107], v[120:135]
ds_read_b64_tr_b16 v[96:97], v34 offset:45056
ds_read_b64_tr_b16 v[98:99], v34 offset:46080
buffer_load_dwordx4 v56, s[44:47], s92 offen offset:2048 lds
v_mfma_f32_32x32x16_bf16 v[136:151], v[88:91], v[108:111], v[136:151]
ds_read_b128 v[112:115], v29 offset:32768
ds_read_b128 v[116:119], v29 offset:36864
s_waitcnt lgkmcnt(4)
v_mfma_f32_32x32x16_bf16 v[152:167], v[92:95], v[104:107], v[152:167]
ds_read_b64_tr_b16 v[100:101], v35 offset:45056
ds_read_b64_tr_b16 v[102:103], v35 offset:46080
buffer_load_dwordx4 v57, s[44:47], s92 offen offset:3072 lds
v_mfma_f32_32x32x16_bf16 v[168:183], v[92:95], v[108:111], v[168:183]
v_mfma_f32_16x16x32_bf16 v[184:187], v[44:47], v[88:91], v[184:187]
s_waitcnt lgkmcnt(0)
s_waitcnt vmcnt(17)
s_barrier
v_mfma_f32_32x32x16_bf16 v[120:135], v[96:99], v[112:115], v[120:135]
ds_read_b64_tr_b16 v[88:89], v36 offset:0
ds_read_b64_tr_b16 v[90:91], v36 offset:1024
s_lshl_b32 s67, s83, 8
s_lshl_b32 s68, s82, 7
s_add_u32 s67, s67, s68
v_lshlrev_b32 v20, 1, v1
v_add_u32 v20, s67, v20
s_lshl_b32 s67, s83, 1
v_mov_b32 v21, s67
global_load_ushort v22, v20, s[6:7]
global_load_ushort v23, v20, s[8:9]
global_load_ushort v24, v20, s[10:11]
global_load_ushort v25, v20, s[12:13]
global_load_ushort v26, v20, s[14:15]
global_load_ushort v27, v20, s[16:17]
global_load_ushort v64, v21, s[18:19]
global_load_ushort v65, v21, s[20:21]
v_mfma_f32_32x32x16_bf16 v[136:151], v[96:99], v[116:119], v[136:151]
ds_read_b128 v[104:107], v30 offset:0
ds_read_b128 v[108:111], v30 offset:4096
v_mfma_f32_32x32x16_bf16 v[152:167], v[100:103], v[112:115], v[152:167]
ds_read_b64_tr_b16 v[92:93], v37 offset:0
ds_read_b64_tr_b16 v[94:95], v37 offset:1024
s_add_u32 s92, s89, 1
s_sub_u32 s67, s92, 7
s_cmp_ge_u32 s92, 7
s_cselect_b32 s92, s67, s92
s_add_u32 m0, s87, 32768
s_lshl_b32 s92, s92, 16
s_add_u32 s92, s92, s86
buffer_load_dwordx4 v54, s[44:47], s92 offen offset:0 lds
v_mfma_f32_32x32x16_bf16 v[168:183], v[100:103], v[116:119], v[168:183]
buffer_load_dwordx4 v55, s[44:47], s92 offen offset:1024 lds
v_mfma_f32_16x16x32_bf16 v[184:187], v[44:47], v[96:99], v[184:187]
s_waitcnt lgkmcnt(2)
v_mfma_f32_32x32x16_bf16 v[120:135], v[88:91], v[104:107], v[120:135]
ds_read_b64_tr_b16 v[96:97], v36 offset:4096
ds_read_b64_tr_b16 v[98:99], v36 offset:5120
buffer_load_dwordx4 v56, s[44:47], s92 offen offset:2048 lds
v_mfma_f32_32x32x16_bf16 v[136:151], v[88:91], v[108:111], v[136:151]
ds_read_b128 v[112:115], v31 offset:0
ds_read_b128 v[116:119], v31 offset:4096
s_waitcnt lgkmcnt(4)
v_mfma_f32_32x32x16_bf16 v[152:167], v[92:95], v[104:107], v[152:167]
ds_read_b64_tr_b16 v[100:101], v37 offset:4096
ds_read_b64_tr_b16 v[102:103], v37 offset:5120
buffer_load_dwordx4 v57, s[44:47], s92 offen offset:3072 lds
v_mfma_f32_32x32x16_bf16 v[168:183], v[92:95], v[108:111], v[168:183]
v_mfma_f32_16x16x32_bf16 v[184:187], v[44:47], v[88:91], v[184:187]
s_waitcnt lgkmcnt(2)
v_mfma_f32_32x32x16_bf16 v[120:135], v[96:99], v[112:115], v[120:135]
ds_read_b64_tr_b16 v[88:89], v36 offset:8192
ds_read_b64_tr_b16 v[90:91], v36 offset:9216
s_add_u32 m0, s87, 36864
s_add_u32 s92, s92, 32768
buffer_load_dwordx4 v54, s[44:47], s92 offen offset:0 lds
v_mfma_f32_32x32x16_bf16 v[136:151], v[96:99], v[116:119], v[136:151]
ds_read_b128 v[104:107], v32 offset:0
ds_read_b128 v[108:111], v32 offset:4096
s_waitcnt lgkmcnt(4)
v_mfma_f32_32x32x16_bf16 v[152:167], v[100:103], v[112:115], v[152:167]
ds_read_b64_tr_b16 v[92:93], v37 offset:8192
ds_read_b64_tr_b16 v[94:95], v37 offset:9216
buffer_load_dwordx4 v55, s[44:47], s92 offen offset:1024 lds
v_mfma_f32_32x32x16_bf16 v[168:183], v[100:103], v[116:119], v[168:183]
v_mfma_f32_16x16x32_bf16 v[184:187], v[44:47], v[96:99], v[184:187]
v_and_b32 v20, 31, v1
v_lshlrev_b32 v20, 4, v20
s_lshl_b32 s57, s52, 11
s_lshl_b32 s60, s79, 10
s_add_u32 s57, s57, s60
s_add_u32 s57, s57, 2097152
v_add_u32 v20, s57, v20
buffer_load_dwordx4 v[188:191], v20, s[48:51], 0 offen sc1
buffer_load_dwordx4 v[192:195], v20, s[48:51], 0 offen offset:512 sc1
s_waitcnt lgkmcnt(2)
v_mfma_f32_32x32x16_bf16 v[120:135], v[88:91], v[104:107], v[120:135]
ds_read_b64_tr_b16 v[96:97], v36 offset:12288
ds_read_b64_tr_b16 v[98:99], v36 offset:13312
buffer_load_dwordx4 v56, s[44:47], s92 offen offset:2048 lds
v_mfma_f32_32x32x16_bf16 v[136:151], v[88:91], v[108:111], v[136:151]
ds_read_b128 v[112:115], v33 offset:0
ds_read_b128 v[116:119], v33 offset:4096
s_waitcnt lgkmcnt(4)
v_mfma_f32_32x32x16_bf16 v[152:167], v[92:95], v[104:107], v[152:167]
ds_read_b64_tr_b16 v[100:101], v37 offset:12288
ds_read_b64_tr_b16 v[102:103], v37 offset:13312
buffer_load_dwordx4 v57, s[44:47], s92 offen offset:3072 lds
v_mfma_f32_32x32x16_bf16 v[168:183], v[92:95], v[108:111], v[168:183]
v_mfma_f32_16x16x32_bf16 v[184:187], v[44:47], v[88:91], v[184:187]
s_waitcnt lgkmcnt(0)
s_waitcnt vmcnt(26)
s_barrier
v_mfma_f32_32x32x16_bf16 v[120:135], v[96:99], v[112:115], v[120:135]
ds_read_b64_tr_b16 v[88:89], v36 offset:32768
ds_read_b64_tr_b16 v[90:91], v36 offset:33792
s_add_u32 s92, s89, 2
s_sub_u32 s67, s92, 7
s_cmp_ge_u32 s92, 7
s_cselect_b32 s92, s67, s92
s_add_u32 m0, s87, 65536
s_lshl_b32 s92, s92, 16
s_add_u32 s92, s92, s86
buffer_load_dwordx4 v54, s[44:47], s92 offen offset:0 lds
v_mfma_f32_32x32x16_bf16 v[136:151], v[96:99], v[116:119], v[136:151]
ds_read_b128 v[104:107], v30 offset:32768
ds_read_b128 v[108:111], v30 offset:36864
v_mfma_f32_32x32x16_bf16 v[152:167], v[100:103], v[112:115], v[152:167]
ds_read_b64_tr_b16 v[92:93], v37 offset:32768
ds_read_b64_tr_b16 v[94:95], v37 offset:33792
buffer_load_dwordx4 v55, s[44:47], s92 offen offset:1024 lds
v_mfma_f32_32x32x16_bf16 v[168:183], v[100:103], v[116:119], v[168:183]
v_mfma_f32_16x16x32_bf16 v[184:187], v[44:47], v[96:99], v[184:187]
s_waitcnt lgkmcnt(2)
v_mfma_f32_32x32x16_bf16 v[120:135], v[88:91], v[104:107], v[120:135]
ds_read_b64_tr_b16 v[96:97], v36 offset:36864
ds_read_b64_tr_b16 v[98:99], v36 offset:37888
buffer_load_dwordx4 v56, s[44:47], s92 offen offset:2048 lds
s_lshl_b32 s96, s78, 1
s_add_u32 s96, s96, s79
v_mfma_f32_32x32x16_bf16 v[136:151], v[88:91], v[108:111], v[136:151]
ds_read_b128 v[112:115], v31 offset:32768
ds_read_b128 v[116:119], v31 offset:36864
s_lshl_b32 s96, s96, 7
s_add_u32 s96, s96, 131072
v_lshlrev_b32 v21, 2, v1
s_waitcnt lgkmcnt(4)
v_mfma_f32_32x32x16_bf16 v[152:167], v[92:95], v[104:107], v[152:167]
ds_read_b64_tr_b16 v[100:101], v37 offset:36864
ds_read_b64_tr_b16 v[102:103], v37 offset:37888
buffer_load_dwordx4 v57, s[44:47], s92 offen offset:3072 lds
v_add_u32 v21, s96, v21
v_and_b32 v66, 31, v1
v_mfma_f32_32x32x16_bf16 v[168:183], v[92:95], v[108:111], v[168:183]
v_lshlrev_b32 v66, 2, v66
v_add_u32 v66, s96, v66
s_lshl_b32 s96, s52, 2
s_lshl_b32 s97, s79, 1
v_mfma_f32_16x16x32_bf16 v[184:187], v[44:47], v[88:91], v[184:187]
s_waitcnt lgkmcnt(2)
v_mfma_f32_32x32x16_bf16 v[120:135], v[96:99], v[112:115], v[120:135]
ds_read_b64_tr_b16 v[88:89], v36 offset:40960
ds_read_b64_tr_b16 v[90:91], v36 offset:41984
s_add_u32 m0, s87, 69632
s_add_u32 s92, s92, 32768
buffer_load_dwordx4 v54, s[44:47], s92 offen offset:0 lds
s_add_u32 s96, s96, s97
s_mul_i32 s96, s96, 112
v_mfma_f32_32x32x16_bf16 v[136:151], v[96:99], v[116:119], v[136:151]
ds_read_b128 v[104:107], v32 offset:32768
ds_read_b128 v[108:111], v32 offset:36864
s_lshl_b32 s97, s53, 3
s_add_u32 s96, s96, s97
s_lshl_b32 s97, s78, 2
s_waitcnt lgkmcnt(4)
v_mfma_f32_32x32x16_bf16 v[152:167], v[100:103], v[112:115], v[152:167]
ds_read_b64_tr_b16 v[92:93], v37 offset:40960
ds_read_b64_tr_b16 v[94:95], v37 offset:41984
buffer_load_dwordx4 v55, s[44:47], s92 offen offset:1024 lds
s_add_u32 s96, s96, s97
s_lshl_b32 s96, s96, 10
v_mfma_f32_32x32x16_bf16 v[168:183], v[100:103], v[116:119], v[168:183]
s_add_u32 s94, s96, 5242880
s_lshl_b32 s96, s56, 30
s_add_u32 s94, s94, s96
s_lshl_b32 s97, s79, 11
v_mfma_f32_16x16x32_bf16 v[184:187], v[44:47], v[96:99], v[184:187]
s_waitcnt lgkmcnt(2)
v_mfma_f32_32x32x16_bf16 v[120:135], v[88:91], v[104:107], v[120:135]
ds_read_b64_tr_b16 v[96:97], v36 offset:45056
ds_read_b64_tr_b16 v[98:99], v36 offset:46080
buffer_load_dwordx4 v56, s[44:47], s92 offen offset:2048 lds
s_xor_b32 s96, s97, 2048
s_add_u32 s95, s94, s96
v_mfma_f32_32x32x16_bf16 v[136:151], v[88:91], v[108:111], v[136:151]
ds_read_b128 v[112:115], v33 offset:32768
ds_read_b128 v[116:119], v33 offset:36864
s_add_u32 s94, s94, s97
s_waitcnt lgkmcnt(4)
v_mfma_f32_32x32x16_bf16 v[152:167], v[92:95], v[104:107], v[152:167]
ds_read_b64_tr_b16 v[100:101], v37 offset:45056
ds_read_b64_tr_b16 v[102:103], v37 offset:46080
buffer_load_dwordx4 v57, s[44:47], s92 offen offset:3072 lds
v_mfma_f32_32x32x16_bf16 v[168:183], v[92:95], v[108:111], v[168:183]
v_mfma_f32_16x16x32_bf16 v[184:187], v[44:47], v[88:91], v[184:187]
s_waitcnt lgkmcnt(0)
v_mfma_f32_32x32x16_bf16 v[120:135], v[96:99], v[112:115], v[120:135]
v_mov_b32 v89, 0
v_mov_b32 v93, 0
v_mfma_f32_32x32x16_bf16 v[136:151], v[96:99], v[116:119], v[136:151]
v_mov_b32 v105, 0
v_mov_b32 v109, 0
v_mov_b32 v90, 0
v_mfma_f32_32x32x16_bf16 v[152:167], v[100:103], v[112:115], v[152:167]
v_mov_b32 v94, 0
v_mov_b32 v106, 0
v_mfma_f32_32x32x16_bf16 v[168:183], v[100:103], v[116:119], v[168:183]
v_mov_b32 v110, 0
v_mov_b32 v91, 0
v_mov_b32 v95, 0
v_mov_b32 v107, 0
v_mfma_f32_16x16x32_bf16 v[184:187], v[44:47], v[96:99], v[184:187]
v_mov_b32 v111, 0
s_waitcnt vmcnt(10)
v_cmp_eq_u64 vcc, s[58:59], v[190:191]
v_cmp_eq_u64 s[70:71], s[58:59], v[194:195]
s_and_b64 vcc, vcc, s[70:71]
s_cmp_eq_u64 vcc, exec
s_cbranch_scc0 L_sp_6
L_sd_7:
s_mov_b64 exec, 0xffff
s_nop 0
v_cvt_pk_bf16_f32 v20, v184, v184
v_cvt_pk_bf16_f32 v86, v185, v185
v_and_b32 v20, 0xffff0000, v20
v_and_b32 v86, 0xffff0000, v86
v_sub_f32 v85, v184, v20
v_sub_f32 v87, v185, v86
v_cvt_pk_bf16_f32 v85, v20, v85
v_cvt_pk_bf16_f32 v87, v86, v87
ds_write_b32 v21, v85
ds_write_b32 v21, v87 offset:64
s_mov_b64 exec, -1
s_waitcnt lgkmcnt(0)
s_barrier
ds_read_b32 v88, v66
v_xor_b32 v66, 128, v66
ds_read_b32 v92, v66
s_mov_b64 vcc, 0xffffffff
s_waitcnt lgkmcnt(0)
s_barrier
v_cndmask_b32 v88, 0, v88, vcc
v_cndmask_b32 v92, 0, v92, vcc
v_cndmask_b32 v104, 0, v188, vcc
v_cndmask_b32 v108, 0, v192, vcc
s_nop 0
v_mfma_f32_32x32x16_bf16 v[120:135], v[88:91], v[104:107], v[120:135]
v_mfma_f32_32x32x16_bf16 v[152:167], v[92:95], v[104:107], v[152:167]
v_mfma_f32_32x32x16_bf16 v[136:151], v[88:91], v[108:111], v[136:151]
v_mfma_f32_32x32x16_bf16 v[168:183], v[92:95], v[108:111], v[168:183]
v_mul_f32 v20, 0xbfb8aa3b, v189
v_mul_f32 v86, 0xbfb8aa3b, v193
s_nop 6
v_pk_mul_f32 v[196:197], v[120:121], v[20:21] op_sel_hi:[1,0]
v_pk_mul_f32 v[198:199], v[122:123], v[20:21] op_sel_hi:[1,0]
v_pk_mul_f32 v[200:201], v[124:125], v[20:21] op_sel_hi:[1,0]
v_pk_mul_f32 v[202:203], v[126:127], v[20:21] op_sel_hi:[1,0]
v_exp_f32 v196, v196
v_exp_f32 v197, v197
v_exp_f32 v198, v198
s_add_u32 s92, s89, 3
s_sub_u32 s67, s92, 7
s_cmp_ge_u32 s92, 7
s_cselect_b32 s92, s67, s92
s_add_u32 m0, s87, 98304
s_lshl_b32 s92, s92, 16
s_add_u32 s92, s92, s86
buffer_load_dwordx4 v54, s[44:47], s92 offen offset:0 lds
v_exp_f32 v199, v199
v_exp_f32 v200, v200
v_exp_f32 v201, v201
v_exp_f32 v202, v202
buffer_load_dwordx4 v55, s[44:47], s92 offen offset:1024 lds
v_exp_f32 v203, v203
v_pk_add_f32 v[196:197], v[196:197], 1.0 op_sel_hi:[1,0]
v_pk_add_f32 v[198:199], v[198:199], 1.0 op_sel_hi:[1,0]
v_pk_add_f32 v[200:201], v[200:201], 1.0 op_sel_hi:[1,0]
v_pk_add_f32 v[202:203], v[202:203], 1.0 op_sel_hi:[1,0]
v_rcp_f32 v196, v196
v_rcp_f32 v197, v197
v_rcp_f32 v198, v198
buffer_load_dwordx4 v56, s[44:47], s92 offen offset:2048 lds
v_rcp_f32 v199, v199
v_rcp_f32 v200, v200
v_rcp_f32 v201, v201
v_rcp_f32 v202, v202
buffer_load_dwordx4 v57, s[44:47], s92 offen offset:3072 lds
v_rcp_f32 v203, v203
v_pk_mul_f32 v[204:205], v[120:121], v[196:197]
v_pk_mul_f32 v[206:207], v[122:123], v[198:199]
v_pk_mul_f32 v[208:209], v[124:125], v[200:201]
v_pk_mul_f32 v[210:211], v[126:127], v[202:203]
v_cvt_pk_bf16_f32 v212, v204, v205
v_cvt_pk_bf16_f32 v213, v206, v207
v_cvt_pk_bf16_f32 v214, v208, v209
v_cvt_pk_bf16_f32 v215, v210, v211
s_add_u32 m0, s87, 102400
s_add_u32 s92, s92, 32768
buffer_load_dwordx4 v54, s[44:47], s92 offen offset:0 lds
s_add_u32 s57, s94, 0
v_permlane32_swap_b32 v212, v214
v_permlane32_swap_b32 v213, v215
buffer_store_dwordx4 v[212:215], v2, s[48:51], s57 offen sc1
v_pk_mul_f32 v[196:197], v[128:129], v[20:21] op_sel_hi:[1,0]
v_pk_mul_f32 v[198:199], v[130:131], v[20:21] op_sel_hi:[1,0]
v_pk_mul_f32 v[200:201], v[132:133], v[20:21] op_sel_hi:[1,0]
v_pk_mul_f32 v[202:203], v[134:135], v[20:21] op_sel_hi:[1,0]
v_exp_f32 v196, v196
v_exp_f32 v197, v197
v_exp_f32 v198, v198
buffer_load_dwordx4 v55, s[44:47], s92 offen offset:1024 lds
v_exp_f32 v199, v199
v_exp_f32 v200, v200
v_exp_f32 v201, v201
v_exp_f32 v202, v202
buffer_load_dwordx4 v56, s[44:47], s92 offen offset:2048 lds
v_exp_f32 v203, v203
v_pk_add_f32 v[196:197], v[196:197], 1.0 op_sel_hi:[1,0]
v_pk_add_f32 v[198:199], v[198:199], 1.0 op_sel_hi:[1,0]
v_pk_add_f32 v[200:201], v[200:201], 1.0 op_sel_hi:[1,0]
v_pk_add_f32 v[202:203], v[202:203], 1.0 op_sel_hi:[1,0]
v_rcp_f32 v196, v196
v_rcp_f32 v197, v197
v_rcp_f32 v198, v198
buffer_load_dwordx4 v57, s[44:47], s92 offen offset:3072 lds
v_rcp_f32 v199, v199
v_rcp_f32 v200, v200
v_rcp_f32 v201, v201
v_rcp_f32 v202, v202
v_rcp_f32 v203, v203
v_pk_mul_f32 v[204:205], v[128:129], v[196:197]
v_pk_mul_f32 v[206:207], v[130:131], v[198:199]
v_pk_mul_f32 v[208:209], v[132:133], v[200:201]
v_pk_mul_f32 v[210:211], v[134:135], v[202:203]
v_cvt_pk_bf16_f32 v216, v204, v205
v_cvt_pk_bf16_f32 v217, v206, v207
v_cvt_pk_bf16_f32 v218, v208, v209
v_cvt_pk_bf16_f32 v219, v210, v211
ds_read_b64_tr_b16 a[0:1], v58 offset:0
ds_read_b64_tr_b16 a[2:3], v58 offset:512
s_add_u32 s57, s94, 1024
v_permlane32_swap_b32 v216, v218
v_permlane32_swap_b32 v217, v219
buffer_store_dwordx4 v[216:219], v2, s[48:51], s57 offen sc1
v_pk_mul_f32 v[196:197], v[152:153], v[20:21] op_sel_hi:[1,0]
v_pk_mul_f32 v[198:199], v[154:155], v[20:21] op_sel_hi:[1,0]
v_pk_mul_f32 v[200:201], v[156:157], v[20:21] op_sel_hi:[1,0]
v_pk_mul_f32 v[202:203], v[158:159], v[20:21] op_sel_hi:[1,0]
v_exp_f32 v196, v196
v_exp_f32 v197, v197
v_exp_f32 v198, v198
ds_read_b64_tr_b16 a[4:5], v59 offset:0
ds_read_b64_tr_b16 a[6:7], v59 offset:512
v_exp_f32 v199, v199
v_exp_f32 v200, v200
v_exp_f32 v201, v201
v_exp_f32 v202, v202
ds_read_b64_tr_b16 a[8:9], v58 offset:2048
ds_read_b64_tr_b16 a[10:11], v58 offset:2560
v_exp_f32 v203, v203
v_pk_add_f32 v[196:197], v[196:197], 1.0 op_sel_hi:[1,0]
v_pk_add_f32 v[198:199], v[198:199], 1.0 op_sel_hi:[1,0]
v_pk_add_f32 v[200:201], v[200:201], 1.0 op_sel_hi:[1,0]
v_pk_add_f32 v[202:203], v[202:203], 1.0 op_sel_hi:[1,0]
v_rcp_f32 v196, v196
v_rcp_f32 v197, v197
v_rcp_f32 v198, v198
ds_read_b64_tr_b16 a[12:13], v59 offset:2048
ds_read_b64_tr_b16 a[14:15], v59 offset:2560
v_rcp_f32 v199, v199
v_rcp_f32 v200, v200
v_rcp_f32 v201, v201
v_rcp_f32 v202, v202
ds_read_b64_tr_b16 a[16:17], v58 offset:4096
ds_read_b64_tr_b16 a[18:19], v58 offset:4608
v_rcp_f32 v203, v203
v_pk_mul_f32 v[204:205], v[152:153], v[196:197]
v_pk_mul_f32 v[206:207], v[154:155], v[198:199]
v_pk_mul_f32 v[208:209], v[156:157], v[200:201]
v_pk_mul_f32 v[210:211], v[158:159], v[202:203]
v_cvt_pk_bf16_f32 v212, v204, v205
v_cvt_pk_bf16_f32 v213, v206, v207
v_cvt_pk_bf16_f32 v214, v208, v209
v_cvt_pk_bf16_f32 v215, v210, v211
ds_read_b64_tr_b16 a[20:21], v59 offset:4096
ds_read_b64_tr_b16 a[22:23], v59 offset:4608
s_add_u32 s57, s95, 0
v_permlane32_swap_b32 v212, v214
v_permlane32_swap_b32 v213, v215
buffer_store_dwordx4 v[212:215], v2, s[48:51], s57 offen sc1
v_pk_mul_f32 v[196:197], v[160:161], v[20:21] op_sel_hi:[1,0]
v_pk_mul_f32 v[198:199], v[162:163], v[20:21] op_sel_hi:[1,0]
v_pk_mul_f32 v[200:201], v[164:165], v[20:21] op_sel_hi:[1,0]
v_pk_mul_f32 v[202:203], v[166:167], v[20:21] op_sel_hi:[1,0]
v_exp_f32 v196, v196
v_exp_f32 v197, v197
v_exp_f32 v198, v198
ds_read_b64_tr_b16 a[24:25], v58 offset:6144
ds_read_b64_tr_b16 a[26:27], v58 offset:6656
v_exp_f32 v199, v199
v_exp_f32 v200, v200
v_exp_f32 v201, v201
v_exp_f32 v202, v202
ds_read_b64_tr_b16 a[28:29], v59 offset:6144
s_waitcnt lgkmcnt(11)
ds_read_b64_tr_b16 a[30:31], v59 offset:6656
v_exp_f32 v203, v203
v_pk_add_f32 v[196:197], v[196:197], 1.0 op_sel_hi:[1,0]
v_pk_add_f32 v[198:199], v[198:199], 1.0 op_sel_hi:[1,0]
v_pk_add_f32 v[200:201], v[200:201], 1.0 op_sel_hi:[1,0]
v_pk_add_f32 v[202:203], v[202:203], 1.0 op_sel_hi:[1,0]
v_rcp_f32 v196, v196
v_rcp_f32 v197, v197
v_rcp_f32 v198, v198
s_add_u32 s92, s89, 4
s_sub_u32 s67, s92, 7
s_cmp_ge_u32 s92, 7
s_cselect_b32 s92, s67, s92
s_add_u32 m0, s87, 131072
s_lshl_b32 s92, s92, 16
s_add_u32 s92, s92, s86
buffer_load_dwordx4 v54, s[44:47], s92 offen offset:0 lds
v_rcp_f32 v199, v199
v_rcp_f32 v200, v200
v_rcp_f32 v201, v201
v_rcp_f32 v202, v202
buffer_load_dwordx4 v55, s[44:47], s92 offen offset:1024 lds
v_rcp_f32 v203, v203
v_pk_mul_f32 v[204:205], v[160:161], v[196:197]
v_pk_mul_f32 v[206:207], v[162:163], v[198:199]
v_pk_mul_f32 v[208:209], v[164:165], v[200:201]
v_pk_mul_f32 v[210:211], v[166:167], v[202:203]
v_cvt_pk_bf16_f32 v216, v204, v205
v_cvt_pk_bf16_f32 v217, v206, v207
v_cvt_pk_bf16_f32 v218, v208, v209
v_cvt_pk_bf16_f32 v219, v210, v211
buffer_load_dwordx4 v56, s[44:47], s92 offen offset:2048 lds
s_add_u32 s57, s95, 1024
v_permlane32_swap_b32 v216, v218
v_permlane32_swap_b32 v217, v219
buffer_store_dwordx4 v[216:219], v2, s[48:51], s57 offen sc1
v_lshlrev_b32 v66, 3, v1
v_add_u32 v66, 2129920, v66
buffer_load_dwordx2 v[220:221], v66, s[48:51], 0 offen offset:0 sc1
buffer_load_dwordx2 v[222:223], v66, s[48:51], 0 offen offset:512 sc1
buffer_load_dwordx2 v[224:225], v66, s[48:51], 0 offen offset:1024 sc1
buffer_load_dwordx2 v[226:227], v66, s[48:51], 0 offen offset:1536 sc1
v_pk_mul_f32 v[196:197], v[136:137], v[86:87] op_sel_hi:[1,0]
v_pk_mul_f32 v[198:199], v[138:139], v[86:87] op_sel_hi:[1,0]
v_pk_mul_f32 v[200:201], v[140:141], v[86:87] op_sel_hi:[1,0]
v_pk_mul_f32 v[202:203], v[142:143], v[86:87] op_sel_hi:[1,0]
v_exp_f32 v196, v196
v_exp_f32 v197, v197
v_exp_f32 v198, v198
buffer_load_dwordx4 v57, s[44:47], s92 offen offset:3072 lds
v_exp_f32 v199, v199
v_exp_f32 v200, v200
v_exp_f32 v201, v201
v_exp_f32 v202, v202
s_add_u32 m0, s87, 135168
s_add_u32 s92, s92, 32768
buffer_load_dwordx4 v54, s[44:47], s92 offen offset:0 lds
v_exp_f32 v203, v203
v_pk_add_f32 v[196:197], v[196:197], 1.0 op_sel_hi:[1,0]
v_pk_add_f32 v[198:199], v[198:199], 1.0 op_sel_hi:[1,0]
v_pk_add_f32 v[200:201], v[200:201], 1.0 op_sel_hi:[1,0]
v_pk_add_f32 v[202:203], v[202:203], 1.0 op_sel_hi:[1,0]
v_rcp_f32 v196, v196
v_rcp_f32 v197, v197
v_rcp_f32 v198, v198
buffer_load_dwordx4 v55, s[44:47], s92 offen offset:1024 lds
v_rcp_f32 v199, v199
v_rcp_f32 v200, v200
v_rcp_f32 v201, v201
v_rcp_f32 v202, v202
buffer_load_dwordx4 v56, s[44:47], s92 offen offset:2048 lds
v_rcp_f32 v203, v203
v_pk_mul_f32 v[204:205], v[136:137], v[196:197]
v_pk_mul_f32 v[206:207], v[138:139], v[198:199]
v_pk_mul_f32 v[208:209], v[140:141], v[200:201]
v_pk_mul_f32 v[210:211], v[142:143], v[202:203]
v_cvt_pk_bf16_f32 v212, v204, v205
v_cvt_pk_bf16_f32 v213, v206, v207
v_cvt_pk_bf16_f32 v214, v208, v209
v_cvt_pk_bf16_f32 v215, v210, v211
buffer_load_dwordx4 v57, s[44:47], s92 offen offset:3072 lds
s_add_u32 s57, s94, 114688
v_permlane32_swap_b32 v212, v214
v_permlane32_swap_b32 v213, v215
buffer_store_dwordx4 v[212:215], v2, s[48:51], s57 offen sc1
v_pk_mul_f32 v[196:197], v[144:145], v[86:87] op_sel_hi:[1,0]
v_pk_mul_f32 v[198:199], v[146:147], v[86:87] op_sel_hi:[1,0]
v_pk_mul_f32 v[200:201], v[148:149], v[86:87] op_sel_hi:[1,0]
v_pk_mul_f32 v[202:203], v[150:151], v[86:87] op_sel_hi:[1,0]
v_exp_f32 v196, v196
v_exp_f32 v197, v197
v_exp_f32 v198, v198
s_waitcnt vmcnt(33)
v_exp_f32 v199, v199
v_exp_f32 v200, v200
v_exp_f32 v201, v201
v_exp_f32 v202, v202
ds_read_b64_tr_b16 a[32:33], v58 offset:32768
ds_read_b64_tr_b16 a[34:35], v58 offset:33280
v_exp_f32 v203, v203
v_pk_add_f32 v[196:197], v[196:197], 1.0 op_sel_hi:[1,0]
v_pk_add_f32 v[198:199], v[198:199], 1.0 op_sel_hi:[1,0]
v_pk_add_f32 v[200:201], v[200:201], 1.0 op_sel_hi:[1,0]
v_pk_add_f32 v[202:203], v[202:203], 1.0 op_sel_hi:[1,0]
v_rcp_f32 v196, v196
v_rcp_f32 v197, v197
v_rcp_f32 v198, v198
ds_read_b64_tr_b16 a[36:37], v59 offset:32768
s_waitcnt lgkmcnt(11)
ds_read_b64_tr_b16 a[38:39], v59 offset:33280
v_rcp_f32 v199, v199
v_rcp_f32 v200, v200
v_rcp_f32 v201, v201
v_rcp_f32 v202, v202
ds_read_b64_tr_b16 a[40:41], v58 offset:34816
ds_read_b64_tr_b16 a[42:43], v58 offset:35328
v_rcp_f32 v203, v203
v_pk_mul_f32 v[204:205], v[144:145], v[196:197]
v_pk_mul_f32 v[206:207], v[146:147], v[198:199]
v_pk_mul_f32 v[208:209], v[148:149], v[200:201]
v_pk_mul_f32 v[210:211], v[150:151], v[202:203]
v_cvt_pk_bf16_f32 v216, v204, v205
v_cvt_pk_bf16_f32 v217, v206, v207
v_cvt_pk_bf16_f32 v218, v208, v209
v_cvt_pk_bf16_f32 v219, v210, v211
ds_read_b64_tr_b16 a[44:45], v59 offset:34816
s_waitcnt lgkmcnt(11)
ds_read_b64_tr_b16 a[46:47], v59 offset:35328
s_add_u32 s57, s94, 115712
v_permlane32_swap_b32 v216, v218
v_permlane32_swap_b32 v217, v219
buffer_store_dwordx4 v[216:219], v2, s[48:51], s57 offen sc1
v_pk_mul_f32 v[196:197], v[168:169], v[86:87] op_sel_hi:[1,0]
v_pk_mul_f32 v[198:199], v[170:171], v[86:87] op_sel_hi:[1,0]
v_pk_mul_f32 v[200:201], v[172:173], v[86:87] op_sel_hi:[1,0]
v_pk_mul_f32 v[202:203], v[174:175], v[86:87] op_sel_hi:[1,0]
v_exp_f32 v196, v196
v_exp_f32 v197, v197
v_exp_f32 v198, v198
ds_read_b64_tr_b16 a[48:49], v58 offset:36864
ds_read_b64_tr_b16 a[50:51], v58 offset:37376
v_exp_f32 v199, v199
v_exp_f32 v200, v200
v_exp_f32 v201, v201
v_exp_f32 v202, v202
ds_read_b64_tr_b16 a[52:53], v59 offset:36864
s_waitcnt lgkmcnt(11)
ds_read_b64_tr_b16 a[54:55], v59 offset:37376
v_exp_f32 v203, v203
v_pk_add_f32 v[196:197], v[196:197], 1.0 op_sel_hi:[1,0]
v_pk_add_f32 v[198:199], v[198:199], 1.0 op_sel_hi:[1,0]
v_pk_add_f32 v[200:201], v[200:201], 1.0 op_sel_hi:[1,0]
v_pk_add_f32 v[202:203], v[202:203], 1.0 op_sel_hi:[1,0]
v_rcp_f32 v196, v196
v_rcp_f32 v197, v197
v_rcp_f32 v198, v198
ds_read_b64_tr_b16 a[56:57], v58 offset:38912
ds_read_b64_tr_b16 a[58:59], v58 offset:39424
v_rcp_f32 v199, v199
v_rcp_f32 v200, v200
v_rcp_f32 v201, v201
v_rcp_f32 v202, v202
ds_read_b64_tr_b16 a[60:61], v59 offset:38912
s_waitcnt lgkmcnt(11)
ds_read_b64_tr_b16 a[62:63], v59 offset:39424
v_rcp_f32 v203, v203
v_pk_mul_f32 v[204:205], v[168:169], v[196:197]
v_pk_mul_f32 v[206:207], v[170:171], v[198:199]
v_pk_mul_f32 v[208:209], v[172:173], v[200:201]
v_pk_mul_f32 v[210:211], v[174:175], v[202:203]
v_cvt_pk_bf16_f32 v212, v204, v205
v_cvt_pk_bf16_f32 v213, v206, v207
v_cvt_pk_bf16_f32 v214, v208, v209
v_cvt_pk_bf16_f32 v215, v210, v211
s_waitcnt vmcnt(26)
s_add_u32 s57, s95, 114688
v_permlane32_swap_b32 v212, v214
v_permlane32_swap_b32 v213, v215
buffer_store_dwordx4 v[212:215], v2, s[48:51], s57 offen sc1
v_pk_mul_f32 v[196:197], v[176:177], v[86:87] op_sel_hi:[1,0]
v_pk_mul_f32 v[198:199], v[178:179], v[86:87] op_sel_hi:[1,0]
v_pk_mul_f32 v[200:201], v[180:181], v[86:87] op_sel_hi:[1,0]
v_pk_mul_f32 v[202:203], v[182:183], v[86:87] op_sel_hi:[1,0]
v_exp_f32 v196, v196
v_exp_f32 v197, v197
v_exp_f32 v198, v198
ds_read_b64_tr_b16 a[64:65], v60 offset:0
ds_read_b64_tr_b16 a[66:67], v60 offset:512
v_exp_f32 v199, v199
v_exp_f32 v200, v200
v_exp_f32 v201, v201
v_exp_f32 v202, v202
ds_read_b64_tr_b16 a[68:69], v61 offset:0
s_waitcnt lgkmcnt(11)
ds_read_b64_tr_b16 a[70:71], v61 offset:512
v_exp_f32 v203, v203
v_pk_add_f32 v[196:197], v[196:197], 1.0 op_sel_hi:[1,0]
v_pk_add_f32 v[198:199], v[198:199], 1.0 op_sel_hi:[1,0]
v_pk_add_f32 v[200:201], v[200:201], 1.0 op_sel_hi:[1,0]
v_pk_add_f32 v[202:203], v[202:203], 1.0 op_sel_hi:[1,0]
v_rcp_f32 v196, v196
v_rcp_f32 v197, v197
v_rcp_f32 v198, v198
ds_read_b64_tr_b16 a[72:73], v60 offset:2048
ds_read_b64_tr_b16 a[74:75], v60 offset:2560
v_rcp_f32 v199, v199
v_rcp_f32 v200, v200
v_rcp_f32 v201, v201
v_rcp_f32 v202, v202
ds_read_b64_tr_b16 a[76:77], v61 offset:2048
s_waitcnt lgkmcnt(11)
ds_read_b64_tr_b16 a[78:79], v61 offset:2560
v_rcp_f32 v203, v203
v_pk_mul_f32 v[204:205], v[176:177], v[196:197]
v_pk_mul_f32 v[206:207], v[178:179], v[198:199]
v_pk_mul_f32 v[208:209], v[180:181], v[200:201]
v_pk_mul_f32 v[210:211], v[182:183], v[202:203]
v_cvt_pk_bf16_f32 v216, v204, v205
v_cvt_pk_bf16_f32 v217, v206, v207
v_cvt_pk_bf16_f32 v218, v208, v209
v_cvt_pk_bf16_f32 v219, v210, v211
ds_read_b64_tr_b16 a[80:81], v60 offset:4096
ds_read_b64_tr_b16 a[82:83], v60 offset:4608
s_add_u32 s57, s95, 115712
v_permlane32_swap_b32 v216, v218
v_permlane32_swap_b32 v217, v219
buffer_store_dwordx4 v[216:219], v2, s[48:51], s57 offen sc1
ds_read_b64_tr_b16 a[84:85], v61 offset:4096
s_waitcnt lgkmcnt(11)
ds_read_b64_tr_b16 a[86:87], v61 offset:4608
ds_read_b64_tr_b16 a[88:89], v60 offset:6144
ds_read_b64_tr_b16 a[90:91], v60 offset:6656
ds_read_b64_tr_b16 a[92:93], v61 offset:6144
s_waitcnt lgkmcnt(11)
ds_read_b64_tr_b16 a[94:95], v61 offset:6656
s_waitcnt lgkmcnt(0)
s_barrier
s_waitcnt vmcnt(9)
v_cmp_eq_u64 vcc, s[58:59], v[220:221]
v_cmp_eq_u64 s[70:71], s[58:59], v[222:223]
s_and_b64 vcc, vcc, s[70:71]
v_cmp_eq_u64 s[70:71], s[58:59], v[224:225]
s_and_b64 vcc, vcc, s[70:71]
v_cmp_eq_u64 s[70:71], s[58:59], v[226:227]
s_and_b64 vcc, vcc, s[70:71]
s_cmp_eq_u64 vcc, exec
s_cbranch_scc0 L_pp_8
L_pd_9:
v_lshlrev_b32 v3, 13, v0
s_lshl_b32 s57, s80, 4
buffer_load_dwordx4 v[4:7], v3, s[48:51], s57 offen sc1
buffer_load_dwordx4 v[8:11], v3, s[48:51], s57 offen offset:16 sc1
v_lshlrev_b32 v22, 16, v22
v_lshlrev_b32 v23, 16, v23
v_lshlrev_b32 v24, 16, v24
v_lshlrev_b32 v25, 16, v25
v_lshlrev_b32 v26, 16, v26
v_lshlrev_b32 v27, 16, v27
v_lshlrev_b32 v64, 16, v64
v_lshlrev_b32 v65, 16, v65
v_mul_f32 v3, 0x3fb8aa3b, v64
v_exp_f32 v3, v3
s_nop 0
v_cvt_pk_bf16_f32 v3, v3, v3
v_and_b32 v3, 0xffff0000, v3
v_mul_f32 v12, v3, v22
v_mul_f32 v13, v3, v23
v_mul_f32 v12, 0x3fb8aa3b, v12
v_mul_f32 v13, 0x3e22f983, v13
v_mul_f32 v20, v3, v24
v_mul_f32 v21, v3, v25
v_mov_b32 v30, v26
v_mov_b32 v31, v27
v_pk_mul_f32 v[28:29], v[30:31], v[20:21] op_sel_hi:[1,0]
v_pk_fma_f32 v[18:19], v[30:31], v[20:21], v[28:29] op_sel:[1,1,0] op_sel_hi:[0,1,1] neg_lo:[1,0,0]
v_mul_f32 v14, 0x41000000, v12
v_mul_f32 v15, 0x41000000, v13
v_exp_f32 v14, v14
v_fract_f32 v15, v15
v_cos_f32 v16, v15
v_sin_f32 v15, v15
v_mul_f32 v44, v14, v16
v_mul_f32 v45, v14, v15
v_mul_f32 v14, 1.0, v12
v_mul_f32 v15, 1.0, v13
v_exp_f32 v14, v14
v_fract_f32 v15, v15
v_cos_f32 v16, v15
v_sin_f32 v15, v15
v_mul_f32 v32, v14, v16
v_mul_f32 v33, v14, v15
v_mul_f32 v14, 0x43800000, v12
v_mul_f32 v15, 0x43800000, v13
v_exp_f32 v14, v14
v_fract_f32 v15, v15
v_cos_f32 v16, v15
v_sin_f32 v15, v15
v_mul_f32 v46, v14, v16
v_mul_f32 v47, v14, v15
v_pk_mul_f32 v[28:29], v[32:33], v[32:33] op_sel_hi:[1,0]
v_pk_fma_f32 v[34:35], v[32:33], v[32:33], v[28:29] op_sel:[1,1,0] op_sel_hi:[0,1,1] neg_lo:[1,0,0]
v_pk_mul_f32 v[28:29], v[34:35], v[34:35] op_sel_hi:[1,0]
v_pk_fma_f32 v[36:37], v[34:35], v[34:35], v[28:29] op_sel:[1,1,0] op_sel_hi:[0,1,1] neg_lo:[1,0,0]
v_xor_b32 v17, 16, v67
v_xor_b32 v66, 32, v67
v_xor_b32 v85, 48, v67
v_xor_b32 v86, 64, v67
v_xor_b32 v87, 80, v67
v_xor_b32 v88, 96, v67
v_xor_b32 v89, 112, v67
v_xor_b32 v90, 128, v67
v_xor_b32 v91, 144, v67
v_xor_b32 v92, 160, v67
v_xor_b32 v93, 176, v67
v_xor_b32 v94, 192, v67
v_xor_b32 v95, 208, v67
v_xor_b32 v96, 224, v67
v_xor_b32 v97, 240, v67
v_pk_mul_f32 v[28:29], v[44:45], v[44:45] op_sel_hi:[1,0]
v_pk_fma_f32 v[98:99], v[44:45], v[44:45], v[28:29] op_sel:[1,1,0] op_sel_hi:[0,1,1] neg_lo:[1,0,0]
v_mov_b32 v106, 1.0
v_cvt_pk_bf16_f32 v102, v44, -v45
v_cvt_pk_bf16_f32 v104, v18, v19
v_mov_b32 v107, 0
ds_write_b32 v17, v102 offset:512
ds_write_b32 v67, v104 offset:16384
v_cvt_pk_bf16_f32 v100, v106, -v107
v_pk_mul_f32 v[116:117], v[44:45], v[98:99] op_sel_hi:[1,0]
v_pk_mul_f32 v[118:119], v[18:19], v[32:33] op_sel_hi:[1,0]
ds_write_b32 v67, v100 offset:0
v_pk_fma_f32 v[112:113], v[44:45], v[98:99], v[116:117] op_sel:[1,1,0] op_sel_hi:[0,1,1] neg_lo:[1,0,0]
v_pk_fma_f32 v[120:121], v[18:19], v[32:33], v[118:119] op_sel:[1,1,0] op_sel_hi:[0,1,1] neg_lo:[1,0,0]
v_mov_b32 v108, v98
v_cvt_pk_bf16_f32 v103, v112, -v113
v_cvt_pk_bf16_f32 v105, v120, v121
v_mov_b32 v109, v99
ds_write_b32 v85, v103 offset:1536
ds_write_b32 v17, v105 offset:16896
v_cvt_pk_bf16_f32 v101, v108, -v109
v_pk_mul_f32 v[116:117], v[112:113], v[98:99] op_sel_hi:[1,0]
v_pk_mul_f32 v[118:119], v[120:121], v[32:33] op_sel_hi:[1,0]
ds_write_b32 v66, v101 offset:1024
v_pk_fma_f32 v[110:111], v[112:113], v[98:99], v[116:117] op_sel:[1,1,0] op_sel_hi:[0,1,1] neg_lo:[1,0,0]
v_pk_fma_f32 v[122:123], v[120:121], v[32:33], v[118:119] op_sel:[1,1,0] op_sel_hi:[0,1,1] neg_lo:[1,0,0]
v_pk_mul_f32 v[114:115], v[108:109], v[98:99] op_sel_hi:[1,0]
v_cvt_pk_bf16_f32 v102, v110, -v111
v_cvt_pk_bf16_f32 v104, v122, v123
v_pk_fma_f32 v[106:107], v[108:109], v[98:99], v[114:115] op_sel:[1,1,0] op_sel_hi:[0,1,1] neg_lo:[1,0,0]
ds_write_b32 v87, v102 offset:2560
ds_write_b32 v66, v104 offset:17408
v_cvt_pk_bf16_f32 v100, v106, -v107
v_pk_mul_f32 v[116:117], v[110:111], v[98:99] op_sel_hi:[1,0]
v_pk_mul_f32 v[118:119], v[122:123], v[32:33] op_sel_hi:[1,0]
ds_write_b32 v86, v100 offset:2048
v_pk_fma_f32 v[112:113], v[110:111], v[98:99], v[116:117] op_sel:[1,1,0] op_sel_hi:[0,1,1] neg_lo:[1,0,0]
v_pk_fma_f32 v[120:121], v[122:123], v[32:33], v[118:119] op_sel:[1,1,0] op_sel_hi:[0,1,1] neg_lo:[1,0,0]
v_pk_mul_f32 v[114:115], v[106:107], v[98:99] op_sel_hi:[1,0]
v_cvt_pk_bf16_f32 v103, v112, -v113
v_cvt_pk_bf16_f32 v105, v120, v121
v_pk_fma_f32 v[108:109], v[106:107], v[98:99], v[114:115] op_sel:[1,1,0] op_sel_hi:[0,1,1] neg_lo:[1,0,0]
ds_write_b32 v89, v103 offset:3584
ds_write_b32 v85, v105 offset:17920
v_cvt_pk_bf16_f32 v101, v108, -v109
v_pk_mul_f32 v[116:117], v[112:113], v[98:99] op_sel_hi:[1,0]
v_pk_mul_f32 v[118:119], v[120:121], v[32:33] op_sel_hi:[1,0]
ds_write_b32 v88, v101 offset:3072
v_pk_fma_f32 v[110:111], v[112:113], v[98:99], v[116:117] op_sel:[1,1,0] op_sel_hi:[0,1,1] neg_lo:[1,0,0]
v_pk_fma_f32 v[122:123], v[120:121], v[32:33], v[118:119] op_sel:[1,1,0] op_sel_hi:[0,1,1] neg_lo:[1,0,0]
v_pk_mul_f32 v[114:115], v[108:109], v[98:99] op_sel_hi:[1,0]
v_cvt_pk_bf16_f32 v102, v110, -v111
v_cvt_pk_bf16_f32 v104, v122, v123
v_pk_fma_f32 v[106:107], v[108:109], v[98:99], v[114:115] op_sel:[1,1,0] op_sel_hi:[0,1,1] neg_lo:[1,0,0]
ds_write_b32 v91, v102 offset:4608
ds_write_b32 v86, v104 offset:18432
v_cvt_pk_bf16_f32 v100, v106, -v107
v_pk_mul_f32 v[116:117], v[110:111], v[98:99] op_sel_hi:[1,0]
v_pk_mul_f32 v[118:119], v[122:123], v[32:33] op_sel_hi:[1,0]
ds_write_b32 v90, v100 offset:4096
v_pk_fma_f32 v[112:113], v[110:111], v[98:99], v[116:117] op_sel:[1,1,0] op_sel_hi:[0,1,1] neg_lo:[1,0,0]
v_pk_fma_f32 v[120:121], v[122:123], v[32:33], v[118:119] op_sel:[1,1,0] op_sel_hi:[0,1,1] neg_lo:[1,0,0]
v_pk_mul_f32 v[114:115], v[106:107], v[98:99] op_sel_hi:[1,0]
v_cvt_pk_bf16_f32 v103, v112, -v113
v_cvt_pk_bf16_f32 v105, v120, v121
v_pk_fma_f32 v[108:109], v[106:107], v[98:99], v[114:115] op_sel:[1,1,0] op_sel_hi:[0,1,1] neg_lo:[1,0,0]
s_waitcnt lgkmcnt(11)
ds_write_b32 v93, v103 offset:5632
ds_write_b32 v87, v105 offset:18944
v_cvt_pk_bf16_f32 v101, v108, -v109
v_pk_mul_f32 v[116:117], v[112:113], v[98:99] op_sel_hi:[1,0]
v_pk_mul_f32 v[118:119], v[120:121], v[32:33] op_sel_hi:[1,0]
ds_write_b32 v92, v101 offset:5120
v_pk_fma_f32 v[110:111], v[112:113], v[98:99], v[116:117] op_sel:[1,1,0] op_sel_hi:[0,1,1] neg_lo:[1,0,0]
v_pk_fma_f32 v[122:123], v[120:121], v[32:33], v[118:119] op_sel:[1,1,0] op_sel_hi:[0,1,1] neg_lo:[1,0,0]
v_pk_mul_f32 v[114:115], v[108:109], v[98:99] op_sel_hi:[1,0]
v_cvt_pk_bf16_f32 v102, v110, -v111
v_cvt_pk_bf16_f32 v104, v122, v123
v_pk_fma_f32 v[106:107], v[108:109], v[98:99], v[114:115] op_sel:[1,1,0] op_sel_hi:[0,1,1] neg_lo:[1,0,0]
ds_write_b32 v95, v102 offset:6656
s_waitcnt lgkmcnt(11)
ds_write_b32 v88, v104 offset:19456
v_cvt_pk_bf16_f32 v100, v106, -v107
v_pk_mul_f32 v[116:117], v[110:111], v[98:99] op_sel_hi:[1,0]
v_pk_mul_f32 v[118:119], v[122:123], v[32:33] op_sel_hi:[1,0]
ds_write_b32 v94, v100 offset:6144
v_pk_fma_f32 v[112:113], v[110:111], v[98:99], v[116:117] op_sel:[1,1,0] op_sel_hi:[0,1,1] neg_lo:[1,0,0]
v_pk_fma_f32 v[120:121], v[122:123], v[32:33], v[118:119] op_sel:[1,1,0] op_sel_hi:[0,1,1] neg_lo:[1,0,0]
v_pk_mul_f32 v[114:115], v[106:107], v[98:99] op_sel_hi:[1,0]
v_cvt_pk_bf16_f32 v103, v112, -v113
v_cvt_pk_bf16_f32 v105, v120, v121
v_pk_fma_f32 v[108:109], v[106:107], v[98:99], v[114:115] op_sel:[1,1,0] op_sel_hi:[0,1,1] neg_lo:[1,0,0]
ds_write_b32 v97, v103 offset:7680
ds_write_b32 v89, v105 offset:19968
v_cvt_pk_bf16_f32 v101, v108, -v109
v_pk_mul_f32 v[116:117], v[112:113], v[98:99] op_sel_hi:[1,0]
v_pk_mul_f32 v[118:119], v[18:19], v[46:47] op_sel_hi:[1,0]
s_waitcnt lgkmcnt(11)
ds_write_b32 v96, v101 offset:7168
v_pk_fma_f32 v[110:111], v[112:113], v[98:99], v[116:117] op_sel:[1,1,0] op_sel_hi:[0,1,1] neg_lo:[1,0,0]
v_pk_fma_f32 v[126:127], v[18:19], v[46:47], v[118:119] op_sel:[1,1,0] op_sel_hi:[0,1,1] neg_lo:[1,0,0]
v_pk_mul_f32 v[114:115], v[108:109], v[98:99] op_sel_hi:[1,0]
v_cvt_pk_bf16_f32 v102, v110, -v111
v_cvt_pk_bf16_f32 v104, v126, v127
v_pk_fma_f32 v[106:107], v[108:109], v[98:99], v[114:115] op_sel:[1,1,0] op_sel_hi:[0,1,1] neg_lo:[1,0,0]
ds_write_b32 v17, v102 offset:8704
ds_write_b32 v90, v104 offset:20480
v_cvt_pk_bf16_f32 v100, v106, -v107
v_pk_mul_f32 v[116:117], v[110:111], v[98:99] op_sel_hi:[1,0]
v_pk_mul_f32 v[118:119], v[126:127], v[34:35] op_sel_hi:[1,0]
ds_write_b32 v67, v100 offset:8192
v_pk_fma_f32 v[112:113], v[110:111], v[98:99], v[116:117] op_sel:[1,1,0] op_sel_hi:[0,1,1] neg_lo:[1,0,0]
v_pk_fma_f32 v[120:121], v[126:127], v[34:35], v[118:119] op_sel:[1,1,0] op_sel_hi:[0,1,1] neg_lo:[1,0,0]
v_pk_mul_f32 v[114:115], v[106:107], v[98:99] op_sel_hi:[1,0]
v_cvt_pk_bf16_f32 v103, v112, -v113
v_cvt_pk_bf16_f32 v105, v120, v121
v_pk_fma_f32 v[108:109], v[106:107], v[98:99], v[114:115] op_sel:[1,1,0] op_sel_hi:[0,1,1] neg_lo:[1,0,0]
s_waitcnt lgkmcnt(11)
ds_write_b32 v85, v103 offset:9728
ds_write_b32 v91, v105 offset:20992
v_cvt_pk_bf16_f32 v101, v108, -v109
v_pk_mul_f32 v[116:117], v[112:113], v[98:99] op_sel_hi:[1,0]
v_pk_mul_f32 v[118:119], v[120:121], v[34:35] op_sel_hi:[1,0]
ds_write_b32 v66, v101 offset:9216
v_pk_fma_f32 v[110:111], v[112:113], v[98:99], v[116:117] op_sel:[1,1,0] op_sel_hi:[0,1,1] neg_lo:[1,0,0]
v_pk_fma_f32 v[122:123], v[120:121], v[34:35], v[118:119] op_sel:[1,1,0] op_sel_hi:[0,1,1] neg_lo:[1,0,0]
v_pk_mul_f32 v[114:115], v[108:109], v[98:99] op_sel_hi:[1,0]
v_cvt_pk_bf16_f32 v102, v110, -v111
v_cvt_pk_bf16_f32 v104, v122, v123
v_pk_fma_f32 v[106:107], v[108:109], v[98:99], v[114:115] op_sel:[1,1,0] op_sel_hi:[0,1,1] neg_lo:[1,0,0]
ds_write_b32 v87, v102 offset:10752
s_waitcnt lgkmcnt(11)
ds_write_b32 v92, v104 offset:21504
v_cvt_pk_bf16_f32 v100, v106, -v107
v_pk_mul_f32 v[116:117], v[110:111], v[98:99] op_sel_hi:[1,0]
v_pk_mul_f32 v[118:119], v[122:123], v[34:35] op_sel_hi:[1,0]
ds_write_b32 v86, v100 offset:10240
v_pk_fma_f32 v[112:113], v[110:111], v[98:99], v[116:117] op_sel:[1,1,0] op_sel_hi:[0,1,1] neg_lo:[1,0,0]
v_pk_fma_f32 v[120:121], v[122:123], v[34:35], v[118:119] op_sel:[1,1,0] op_sel_hi:[0,1,1] neg_lo:[1,0,0]
v_pk_mul_f32 v[114:115], v[106:107], v[98:99] op_sel_hi:[1,0]
v_cvt_pk_bf16_f32 v103, v112, -v113
v_cvt_pk_bf16_f32 v105, v120, v121
v_pk_fma_f32 v[108:109], v[106:107], v[98:99], v[114:115] op_sel:[1,1,0] op_sel_hi:[0,1,1] neg_lo:[1,0,0]
ds_write_b32 v89, v103 offset:11776
ds_write_b32 v93, v105 offset:22016
v_cvt_pk_bf16_f32 v101, v108, -v109
v_pk_mul_f32 v[116:117], v[112:113], v[98:99] op_sel_hi:[1,0]
v_pk_mul_f32 v[118:119], v[126:127], v[46:47] op_sel_hi:[1,0]
s_waitcnt lgkmcnt(11)
ds_write_b32 v88, v101 offset:11264
v_pk_fma_f32 v[110:111], v[112:113], v[98:99], v[116:117] op_sel:[1,1,0] op_sel_hi:[0,1,1] neg_lo:[1,0,0]
v_pk_fma_f32 v[128:129], v[126:127], v[46:47], v[118:119] op_sel:[1,1,0] op_sel_hi:[0,1,1] neg_lo:[1,0,0]
v_pk_mul_f32 v[114:115], v[108:109], v[98:99] op_sel_hi:[1,0]
v_cvt_pk_bf16_f32 v102, v110, -v111
v_cvt_pk_bf16_f32 v104, v128, v129
v_pk_fma_f32 v[106:107], v[108:109], v[98:99], v[114:115] op_sel:[1,1,0] op_sel_hi:[0,1,1] neg_lo:[1,0,0]
ds_write_b32 v91, v102 offset:12800
ds_write_b32 v94, v104 offset:22528
v_cvt_pk_bf16_f32 v100, v106, -v107
v_pk_mul_f32 v[116:117], v[110:111], v[98:99] op_sel_hi:[1,0]
v_pk_mul_f32 v[118:119], v[128:129], v[36:37] op_sel_hi:[1,0]
ds_write_b32 v90, v100 offset:12288
v_pk_fma_f32 v[112:113], v[110:111], v[98:99], v[116:117] op_sel:[1,1,0] op_sel_hi:[0,1,1] neg_lo:[1,0,0]
v_pk_fma_f32 v[124:125], v[128:129], v[36:37], v[118:119] op_sel:[1,1,0] op_sel_hi:[0,1,1] neg_lo:[1,0,0]
v_pk_mul_f32 v[114:115], v[106:107], v[98:99] op_sel_hi:[1,0]
v_cvt_pk_bf16_f32 v103, v112, -v113
v_cvt_pk_bf16_f32 v105, v124, v125
v_pk_fma_f32 v[108:109], v[106:107], v[98:99], v[114:115] op_sel:[1,1,0] op_sel_hi:[0,1,1] neg_lo:[1,0,0]
s_waitcnt lgkmcnt(11)
ds_write_b32 v93, v103 offset:13824
ds_write_b32 v67, v105 offset:24576
v_cvt_pk_bf16_f32 v101, v108, -v109
v_pk_mul_f32 v[116:117], v[112:113], v[98:99] op_sel_hi:[1,0]
v_pk_mul_f32 v[118:119], v[128:129], v[46:47] op_sel_hi:[1,0]
ds_write_b32 v92, v101 offset:13312
v_pk_fma_f32 v[110:111], v[112:113], v[98:99], v[116:117] op_sel:[1,1,0] op_sel_hi:[0,1,1] neg_lo:[1,0,0]
v_pk_fma_f32 v[126:127], v[128:129], v[46:47], v[118:119] op_sel:[1,1,0] op_sel_hi:[0,1,1] neg_lo:[1,0,0]
v_pk_mul_f32 v[114:115], v[108:109], v[98:99] op_sel_hi:[1,0]
v_cvt_pk_bf16_f32 v102, v110, -v111
v_cvt_pk_bf16_f32 v104, v126, v127
v_pk_fma_f32 v[106:107], v[108:109], v[98:99], v[114:115] op_sel:[1,1,0] op_sel_hi:[0,1,1] neg_lo:[1,0,0]
ds_write_b32 v95, v102 offset:14848
s_waitcnt lgkmcnt(11)
ds_write_b32 v95, v104 offset:23040
v_cvt_pk_bf16_f32 v100, v106, -v107
v_pk_mul_f32 v[116:117], v[110:111], v[98:99] op_sel_hi:[1,0]
v_pk_mul_f32 v[118:119], v[126:127], v[36:37] op_sel_hi:[1,0]
ds_write_b32 v94, v100 offset:14336
v_pk_fma_f32 v[112:113], v[110:111], v[98:99], v[116:117] op_sel:[1,1,0] op_sel_hi:[0,1,1] neg_lo:[1,0,0]
v_pk_fma_f32 v[124:125], v[126:127], v[36:37], v[118:119] op_sel:[1,1,0] op_sel_hi:[0,1,1] neg_lo:[1,0,0]
v_pk_mul_f32 v[114:115], v[106:107], v[98:99] op_sel_hi:[1,0]
v_cvt_pk_bf16_f32 v103, v112, -v113
v_cvt_pk_bf16_f32 v105, v124, v125
v_pk_fma_f32 v[108:109], v[106:107], v[98:99], v[114:115] op_sel:[1,1,0] op_sel_hi:[0,1,1] neg_lo:[1,0,0]
ds_write_b32 v97, v103 offset:15872
ds_write_b32 v17, v105 offset:25088
v_cvt_pk_bf16_f32 v101, v108, -v109
v_pk_mul_f32 v[118:119], v[126:127], v[46:47] op_sel_hi:[1,0]
s_waitcnt lgkmcnt(11)
ds_write_b32 v96, v101 offset:15360
v_pk_fma_f32 v[128:129], v[126:127], v[46:47], v[118:119] op_sel:[1,1,0] op_sel_hi:[0,1,1] neg_lo:[1,0,0]
v_cvt_pk_bf16_f32 v104, v128, v129
ds_write_b32 v96, v104 offset:23552
v_pk_mul_f32 v[118:119], v[128:129], v[46:47] op_sel_hi:[1,0]
v_pk_fma_f32 v[126:127], v[128:129], v[46:47], v[118:119] op_sel:[1,1,0] op_sel_hi:[0,1,1] neg_lo:[1,0,0]
v_cvt_pk_bf16_f32 v105, v126, v127
ds_write_b32 v97, v105 offset:24064
v_pk_mul_f32 v[118:119], v[126:127], v[46:47] op_sel_hi:[1,0]
v_pk_fma_f32 v[128:129], v[126:127], v[46:47], v[118:119] op_sel:[1,1,0] op_sel_hi:[0,1,1] neg_lo:[1,0,0]
v_cvt_pk_bf16_f32 v104, v128, v129
ds_write_b32 v86, v104 offset:26624
v_pk_mul_f32 v[118:119], v[128:129], v[46:47] op_sel_hi:[1,0]
v_pk_fma_f32 v[126:127], v[128:129], v[46:47], v[118:119] op_sel:[1,1,0] op_sel_hi:[0,1,1] neg_lo:[1,0,0]
v_cvt_pk_bf16_f32 v105, v126, v127
s_waitcnt lgkmcnt(11)
ds_write_b32 v87, v105 offset:27136
v_pk_mul_f32 v[118:119], v[126:127], v[46:47] op_sel_hi:[1,0]
v_pk_fma_f32 v[128:129], v[126:127], v[46:47], v[118:119] op_sel:[1,1,0] op_sel_hi:[0,1,1] neg_lo:[1,0,0]
v_cvt_pk_bf16_f32 v104, v128, v129
ds_write_b32 v88, v104 offset:27648
v_xor_b32 v3, 64, v68
v_xor_b32 v12, 128, v68
v_xor_b32 v13, 192, v68
s_lshl_b32 s60, s82, 13
v_add_u32 v17, s60, v68
v_add_u32 v18, s60, v3
v_add_u32 v19, s60, v12
v_add_u32 v20, s60, v13
s_waitcnt lgkmcnt(0)
s_barrier
ds_read_b128 v[24:27], v17 offset:16384
ds_read_b128 v[104:107], v68 offset:0
ds_read_b128 v[136:139], v68 offset:8192
ds_read_b128 v[28:31], v18 offset:16384
ds_read_b128 v[108:111], v3 offset:0
ds_read_b128 v[140:143], v3 offset:8192
ds_read_b128 v[32:35], v19 offset:16384
ds_read_b128 v[112:115], v12 offset:0
ds_read_b128 v[144:147], v12 offset:8192
ds_read_b128 v[44:47], v20 offset:16384
ds_read_b128 v[116:119], v13 offset:0
ds_read_b128 v[148:151], v13 offset:8192
s_waitcnt lgkmcnt(9)
v_mfma_f32_16x16x32_bf16 v[168:171], v[24:27], v[104:107], 0
v_mfma_f32_16x16x32_bf16 v[172:175], v[24:27], v[136:139], 0
ds_read_b128 v[88:91], v17 offset:16640
ds_read_b128 v[120:123], v68 offset:256
ds_read_b128 v[152:155], v68 offset:8448
s_waitcnt lgkmcnt(9)
v_mfma_f32_16x16x32_bf16 v[168:171], v[28:31], v[108:111], v[168:171]
v_mfma_f32_16x16x32_bf16 v[172:175], v[28:31], v[140:143], v[172:175]
ds_read_b128 v[92:95], v18 offset:16640
ds_read_b128 v[124:127], v3 offset:256
ds_read_b128 v[156:159], v3 offset:8448
s_waitcnt lgkmcnt(9)
v_mfma_f32_16x16x32_bf16 v[168:171], v[32:35], v[112:115], v[168:171]
v_mfma_f32_16x16x32_bf16 v[172:175], v[32:35], v[144:147], v[172:175]
ds_read_b128 v[96:99], v19 offset:16640
ds_read_b128 v[128:131], v12 offset:256
ds_read_b128 v[160:163], v12 offset:8448
s_waitcnt lgkmcnt(9)
v_mfma_f32_16x16x32_bf16 v[168:171], v[44:47], v[116:119], v[168:171]
v_mfma_f32_16x16x32_bf16 v[172:175], v[44:47], v[148:151], v[172:175]
ds_read_b128 v[100:103], v20 offset:16640
ds_read_b128 v[132:135], v13 offset:256
ds_read_b128 v[164:167], v13 offset:8448
s_waitcnt lgkmcnt(9)
v_mfma_f32_16x16x32_bf16 v[168:171], v[88:91], v[120:123], v[168:171]
v_mfma_f32_16x16x32_bf16 v[172:175], v[88:91], v[152:155], v[172:175]
s_waitcnt lgkmcnt(6)
v_mfma_f32_16x16x32_bf16 v[168:171], v[92:95], v[124:127], v[168:171]
v_mfma_f32_16x16x32_bf16 v[172:175], v[92:95], v[156:159], v[172:175]
s_waitcnt lgkmcnt(3)
v_mfma_f32_16x16x32_bf16 v[168:171], v[96:99], v[128:131], v[168:171]
v_mfma_f32_16x16x32_bf16 v[172:175], v[96:99], v[160:163], v[172:175]
s_waitcnt lgkmcnt(0)
v_mfma_f32_16x16x32_bf16 v[168:171], v[100:103], v[132:135], v[168:171]
v_mfma_f32_16x16x32_bf16 v[172:175], v[100:103], v[164:167], v[172:175]
s_nop 6
v_cvt_pk_bf16_f32 v14, v168, v168
ds_write_b16 v71, v14
v_cvt_pk_bf16_f32 v15, v172, v172
ds_write_b16 v72, v15
v_cvt_pk_bf16_f32 v16, v169, v169
ds_write_b16 v73, v16
v_cvt_pk_bf16_f32 v21, v173, v173
ds_write_b16 v74, v21
v_cvt_pk_bf16_f32 v14, v170, v170
ds_write_b16 v75, v14
v_cvt_pk_bf16_f32 v15, v174, v174
ds_write_b16 v76, v15
v_cvt_pk_bf16_f32 v16, v171, v171
ds_write_b16 v77, v16
v_cvt_pk_bf16_f32 v21, v175, v175
ds_write_b16 v78, v21
s_mov_b64 s[74:75], exec
s_mov_b64 exec, 1
s_mul_i32 s57, s81, 4352
s_add_u32 s57, s57, 89600
v_mov_b32 v14, s57
v_mov_b32 v15, 0
ds_write_b16 v14, v15
s_mov_b64 exec, s[74:75]
s_waitcnt vmcnt(2)
s_waitcnt lgkmcnt(0)
s_barrier
s_lshl_b32 s60, s55, 3
s_add_u32 s60, s60, 2134016
v_lshlrev_b32 v3, 24, v0
v_mov_b32 v12, s58
v_mov_b32 v13, s59
buffer_store_dwordx2 v[12:13], v3, s[48:51], s60 offen sc1
v_lshlrev_b32 v3, 4, v0
ds_read_u16 v18, v39 offset:0
ds_read_u16 v19, v40 offset:0
ds_read_u16 v20, v41 offset:0
ds_read_u16 v21, v42 offset:0
ds_read_u16 v22, v43 offset:0
ds_read_u16 v23, v48 offset:0
ds_read_u16 v24, v49 offset:0
ds_read_u16 v25, v50 offset:0
ds_read_u16 v26, v51 offset:0
ds_read_u16 v27, v52 offset:0
ds_read_u16 v28, v53 offset:0
ds_read_u16 v86, v39 offset:4352
ds_read_u16 v87, v40 offset:4352
ds_read_u16 v88, v41 offset:4352
ds_read_u16 v89, v42 offset:4352
s_waitcnt lgkmcnt(11)
ds_read_u16 v90, v43 offset:4352
ds_read_u16 v91, v48 offset:4352
ds_read_u16 v92, v49 offset:4352
ds_read_u16 v93, v50 offset:4352
s_waitcnt lgkmcnt(11)
ds_read_u16 v94, v51 offset:4352
ds_read_u16 v95, v52 offset:4352
ds_read_u16 v96, v53 offset:4352
ds_read_u16 v44, v70
s_waitcnt lgkmcnt(11)
ds_read_u16 v45, v79
ds_read_u16 v46, v80
ds_read_u16 v47, v81
v_add_u32 v12, 44032, v3
s_mul_i32 s57, s81, 4608
s_lshl_b32 s60, s82, 8
s_add_u32 s57, s57, s60
s_add_u32 s57, s57, 43520
v_lshlrev_b32 v13, 2, v1
s_waitcnt vmcnt(1)
ds_write_b128 v12, v[4:7]
s_waitcnt lgkmcnt(11)
ds_write_b128 v12, v[8:11] offset:4608
v_add_u32 v12, s57, v13
v_mov_b32 v13, 0
ds_write_b32 v12, v13
v_lshlrev_b32 v30, 16, v18
v_lshl_or_b32 v31, v20, 16, v19
v_lshl_or_b32 v32, v22, 16, v21
v_lshl_or_b32 v33, v24, 16, v23
v_lshl_or_b32 v34, v26, 16, v25
v_lshl_or_b32 v35, v28, 16, v27
ds_write_b128 v3, v[32:35] offset:0
v_alignbit_b32 v106, v32, v31, 16
v_alignbit_b32 v107, v33, v32, 16
v_alignbit_b32 v108, v34, v33, 16
v_alignbit_b32 v109, v35, v34, 16
ds_write_b128 v3, v[106:109] offset:4160
v_alignbit_b32 v110, v31, v30, 16
v_alignbit_b32 v111, v32, v31, 16
v_alignbit_b32 v112, v33, v32, 16
v_alignbit_b32 v113, v34, v33, 16
s_waitcnt lgkmcnt(11)
ds_write_b128 v3, v[110:113] offset:12480
v_mov_b32 v106, v31
v_mov_b32 v107, v32
v_mov_b32 v108, v33
v_mov_b32 v109, v34
ds_write_b128 v3, v[106:109] offset:8320
s_waitcnt lgkmcnt(11)
v_lshlrev_b32 v98, 16, v86
v_lshl_or_b32 v99, v88, 16, v87
v_lshl_or_b32 v100, v90, 16, v89
v_lshl_or_b32 v101, v92, 16, v91
v_lshl_or_b32 v102, v94, 16, v93
v_lshl_or_b32 v103, v96, 16, v95
ds_write_b128 v3, v[100:103] offset:16640
v_alignbit_b32 v114, v100, v99, 16
v_alignbit_b32 v115, v101, v100, 16
v_alignbit_b32 v116, v102, v101, 16
v_alignbit_b32 v117, v103, v102, 16
ds_write_b128 v3, v[114:117] offset:20800
v_alignbit_b32 v118, v99, v98, 16
v_alignbit_b32 v119, v100, v99, 16
v_alignbit_b32 v120, v101, v100, 16
v_alignbit_b32 v121, v102, v101, 16
ds_write_b128 v3, v[118:121] offset:29120
v_mov_b32 v114, v99
v_mov_b32 v115, v100
v_mov_b32 v116, v101
v_mov_b32 v117, v102
ds_write_b128 v3, v[114:117] offset:24960
v_mov_b32 v125, 0
v_mov_b32 v126, 0
v_mov_b32 v127, 0
v_mov_b32 v128, 0
v_mov_b32 v129, 0
s_waitcnt lgkmcnt(11)
v_lshlrev_b32 v122, 16, v44
v_lshl_or_b32 v123, v46, 16, v45
v_mov_b32 v124, v47
s_mov_b64 s[74:75], exec
s_mov_b64 exec, 0x3f
ds_write_b128 v69, v[124:127] offset:0
v_alignbit_b32 v130, v124, v123, 16
v_alignbit_b32 v131, v125, v124, 16
v_alignbit_b32 v132, v126, v125, 16
v_alignbit_b32 v133, v127, v126, 16
ds_write_b128 v69, v[130:133] offset:4160
v_alignbit_b32 v134, v123, v122, 16
v_alignbit_b32 v135, v124, v123, 16
v_alignbit_b32 v136, v125, v124, 16
v_alignbit_b32 v137, v126, v125, 16
ds_write_b128 v69, v[134:137] offset:12480
v_mov_b32 v130, v123
v_mov_b32 v131, v124
v_mov_b32 v132, v125
v_mov_b32 v133, v126
ds_write_b128 v69, v[130:133] offset:8320
s_mov_b64 exec, s[74:75]
s_waitcnt lgkmcnt(0)
s_barrier
ds_read_b64 v[8:9], v82 offset:3776
ds_read_b64 v[10:11], v82 offset:3784
ds_read_b128 v[96:99], v83 offset:192
ds_read_b64 v[12:13], v82 offset:3264
ds_read_b64 v[14:15], v82 offset:3272
ds_read_b128 v[100:103], v83 offset:704
ds_read_b64 v[16:17], v82 offset:2752
ds_read_b64 v[18:19], v82 offset:2760
ds_read_b128 v[104:107], v83 offset:1216
ds_read_b64 v[20:21], v82 offset:2240
ds_read_b64 v[22:23], v82 offset:2248
ds_read_b128 v[108:111], v83 offset:1728
ds_read_b64 v[24:25], v82 offset:1728
ds_read_b64 v[26:27], v82 offset:1736
ds_read_b128 v[112:115], v83 offset:2240
s_waitcnt lgkmcnt(11)
ds_read_b64 v[28:29], v82 offset:1216
ds_read_b64 v[30:31], v82 offset:1224
ds_read_b128 v[116:119], v83 offset:2752
ds_read_b64 v[32:33], v82 offset:704
s_waitcnt lgkmcnt(11)
ds_read_b64 v[34:35], v82 offset:712
ds_read_b128 v[120:123], v83 offset:3264
ds_read_b64 v[36:37], v82 offset:192
ds_read_b64 v[38:39], v82 offset:200
s_waitcnt lgkmcnt(11)
ds_read_b128 v[124:127], v83 offset:3776
v_mfma_f32_16x16x32_bf16 v[160:163], v[8:11], v[96:99], 0
ds_read_b64 v[40:41], v82 offset:3712
v_mfma_f32_16x16x32_bf16 v[164:167], v[8:11], v[100:103], 0
ds_read_b64 v[42:43], v82 offset:3720
v_mfma_f32_16x16x32_bf16 v[164:167], v[12:15], v[96:99], v[164:167]
ds_read_b128 v[128:131], v83 offset:128
v_mfma_f32_16x16x32_bf16 v[168:171], v[8:11], v[104:107], 0
s_waitcnt lgkmcnt(11)
ds_read_b64 v[44:45], v82 offset:3200
v_mfma_f32_16x16x32_bf16 v[168:171], v[12:15], v[100:103], v[168:171]
ds_read_b64 v[46:47], v82 offset:3208
v_mfma_f32_16x16x32_bf16 v[168:171], v[16:19], v[96:99], v[168:171]
ds_read_b128 v[132:135], v83 offset:640
v_mfma_f32_16x16x32_bf16 v[172:175], v[8:11], v[108:111], 0
ds_read_b64 v[48:49], v82 offset:2688
v_mfma_f32_16x16x32_bf16 v[172:175], v[12:15], v[104:107], v[172:175]
s_waitcnt lgkmcnt(11)
ds_read_b64 v[50:51], v82 offset:2696
v_mfma_f32_16x16x32_bf16 v[172:175], v[16:19], v[100:103], v[172:175]
ds_read_b128 v[136:139], v83 offset:1152
v_mfma_f32_16x16x32_bf16 v[172:175], v[20:23], v[96:99], v[172:175]
ds_read_b64 v[68:69], v82 offset:2176
v_mfma_f32_16x16x32_bf16 v[176:179], v[8:11], v[112:115], 0
ds_read_b64 v[70:71], v82 offset:2184
v_mfma_f32_16x16x32_bf16 v[176:179], v[12:15], v[108:111], v[176:179]
s_waitcnt lgkmcnt(11)
ds_read_b128 v[140:143], v83 offset:1664
v_mfma_f32_16x16x32_bf16 v[176:179], v[16:19], v[104:107], v[176:179]
ds_read_b64 v[72:73], v82 offset:1664
v_mfma_f32_16x16x32_bf16 v[176:179], v[20:23], v[100:103], v[176:179]
ds_read_b64 v[74:75], v82 offset:1672
v_mfma_f32_16x16x32_bf16 v[176:179], v[24:27], v[96:99], v[176:179]
ds_read_b128 v[144:147], v83 offset:2176
v_mfma_f32_16x16x32_bf16 v[180:183], v[8:11], v[116:119], 0
s_waitcnt lgkmcnt(11)
ds_read_b64 v[76:77], v82 offset:1152
v_mfma_f32_16x16x32_bf16 v[180:183], v[12:15], v[112:115], v[180:183]
ds_read_b64 v[78:79], v82 offset:1160
v_mfma_f32_16x16x32_bf16 v[180:183], v[16:19], v[108:111], v[180:183]
ds_read_b128 v[148:151], v83 offset:2688
v_mfma_f32_16x16x32_bf16 v[180:183], v[20:23], v[104:107], v[180:183]
ds_read_b64 v[88:89], v82 offset:640
v_mfma_f32_16x16x32_bf16 v[180:183], v[24:27], v[100:103], v[180:183]
s_waitcnt lgkmcnt(11)
ds_read_b64 v[90:91], v82 offset:648
v_mfma_f32_16x16x32_bf16 v[180:183], v[28:31], v[96:99], v[180:183]
ds_read_b128 v[152:155], v83 offset:3200
v_mfma_f32_16x16x32_bf16 v[184:187], v[8:11], v[120:123], 0
ds_read_b64 v[92:93], v82 offset:128
v_mfma_f32_16x16x32_bf16 v[184:187], v[12:15], v[116:119], v[184:187]
ds_read_b64 v[94:95], v82 offset:136
v_mfma_f32_16x16x32_bf16 v[184:187], v[16:19], v[112:115], v[184:187]
s_waitcnt lgkmcnt(11)
ds_read_b128 v[156:159], v83 offset:3712
v_mfma_f32_16x16x32_bf16 v[184:187], v[20:23], v[108:111], v[184:187]
v_mfma_f32_16x16x32_bf16 v[184:187], v[24:27], v[104:107], v[184:187]
ds_read_b64_tr_b16 a[96:97], v60 offset:32768
ds_read_b64_tr_b16 a[98:99], v60 offset:33280
v_mfma_f32_16x16x32_bf16 v[184:187], v[28:31], v[100:103], v[184:187]
ds_read_b64_tr_b16 a[100:101], v61 offset:32768
s_waitcnt lgkmcnt(11)
ds_read_b64_tr_b16 a[102:103], v61 offset:33280
v_mfma_f32_16x16x32_bf16 v[184:187], v[32:35], v[96:99], v[184:187]
ds_read_b64_tr_b16 a[104:105], v60 offset:34816
ds_read_b64_tr_b16 a[106:107], v60 offset:35328
v_mfma_f32_16x16x32_bf16 v[188:191], v[8:11], v[124:127], 0
ds_read_b64_tr_b16 a[108:109], v61 offset:34816
s_waitcnt lgkmcnt(11)
ds_read_b64_tr_b16 a[110:111], v61 offset:35328
v_mfma_f32_16x16x32_bf16 v[188:191], v[12:15], v[120:123], v[188:191]
ds_read_b64_tr_b16 a[112:113], v60 offset:36864
ds_read_b64_tr_b16 a[114:115], v60 offset:37376
v_mfma_f32_16x16x32_bf16 v[188:191], v[16:19], v[116:119], v[188:191]
ds_read_b64_tr_b16 a[116:117], v61 offset:36864
s_waitcnt lgkmcnt(11)
ds_read_b64_tr_b16 a[118:119], v61 offset:37376
v_mfma_f32_16x16x32_bf16 v[188:191], v[20:23], v[112:115], v[188:191]
ds_read_b64_tr_b16 a[120:121], v60 offset:38912
ds_read_b64_tr_b16 a[122:123], v60 offset:39424
v_mfma_f32_16x16x32_bf16 v[188:191], v[24:27], v[108:111], v[188:191]
ds_read_b64_tr_b16 a[124:125], v61 offset:38912
s_waitcnt lgkmcnt(11)
ds_read_b64_tr_b16 a[126:127], v61 offset:39424
v_mfma_f32_16x16x32_bf16 v[188:191], v[28:31], v[104:107], v[188:191]
s_waitcnt lgkmcnt(0)
v_mfma_f32_16x16x32_bf16 v[188:191], v[32:35], v[100:103], v[188:191]
s_add_u32 s92, s89, 5
s_sub_u32 s67, s92, 7
s_cmp_ge_u32 s92, 7
s_cselect_b32 s92, s67, s92
s_add_u32 m0, s87, 98304
s_lshl_b32 s92, s92, 16
s_add_u32 s92, s92, s86
buffer_load_dwordx4 v54, s[44:47], s92 offen offset:0 lds
v_mfma_f32_16x16x32_bf16 v[188:191], v[36:39], v[96:99], v[188:191]
buffer_load_dwordx4 v55, s[44:47], s92 offen offset:1024 lds
v_mfma_f32_16x16x32_bf16 v[160:163], v[40:43], v[128:131], v[160:163]
ds_read_b64 v[8:9], v82 offset:3648
v_mfma_f32_16x16x32_bf16 v[164:167], v[40:43], v[132:135], v[164:167]
ds_read_b64 v[10:11], v82 offset:3656
v_mfma_f32_16x16x32_bf16 v[164:167], v[44:47], v[128:131], v[164:167]
ds_read_b128 v[96:99], v83 offset:64
v_mfma_f32_16x16x32_bf16 v[168:171], v[40:43], v[136:139], v[168:171]
ds_read_b64 v[12:13], v82 offset:3136
v_mfma_f32_16x16x32_bf16 v[168:171], v[44:47], v[132:135], v[168:171]
ds_read_b64 v[14:15], v82 offset:3144
v_mfma_f32_16x16x32_bf16 v[168:171], v[48:51], v[128:131], v[168:171]
ds_read_b128 v[100:103], v83 offset:576
v_mfma_f32_16x16x32_bf16 v[172:175], v[40:43], v[140:143], v[172:175]
ds_read_b64 v[16:17], v82 offset:2624
v_mfma_f32_16x16x32_bf16 v[172:175], v[44:47], v[136:139], v[172:175]
ds_read_b64 v[18:19], v82 offset:2632
v_mfma_f32_16x16x32_bf16 v[172:175], v[48:51], v[132:135], v[172:175]
ds_read_b128 v[104:107], v83 offset:1088
v_mfma_f32_16x16x32_bf16 v[172:175], v[68:71], v[128:131], v[172:175]
ds_read_b64 v[20:21], v82 offset:2112
v_mfma_f32_16x16x32_bf16 v[176:179], v[40:43], v[144:147], v[176:179]
ds_read_b64 v[22:23], v82 offset:2120
v_mfma_f32_16x16x32_bf16 v[176:179], v[44:47], v[140:143], v[176:179]
ds_read_b128 v[108:111], v83 offset:1600
v_mfma_f32_16x16x32_bf16 v[176:179], v[48:51], v[136:139], v[176:179]
ds_read_b64 v[24:25], v82 offset:1600
v_mfma_f32_16x16x32_bf16 v[176:179], v[68:71], v[132:135], v[176:179]
ds_read_b64 v[26:27], v82 offset:1608
v_mfma_f32_16x16x32_bf16 v[176:179], v[72:75], v[128:131], v[176:179]
ds_read_b128 v[112:115], v83 offset:2112
v_mfma_f32_16x16x32_bf16 v[180:183], v[40:43], v[148:151], v[180:183]
s_waitcnt lgkmcnt(11)
ds_read_b64 v[28:29], v82 offset:1088
v_mfma_f32_16x16x32_bf16 v[180:183], v[44:47], v[144:147], v[180:183]
ds_read_b64 v[30:31], v82 offset:1096
v_mfma_f32_16x16x32_bf16 v[180:183], v[48:51], v[140:143], v[180:183]
ds_read_b128 v[116:119], v83 offset:2624
v_mfma_f32_16x16x32_bf16 v[180:183], v[68:71], v[136:139], v[180:183]
ds_read_b64 v[32:33], v82 offset:576
v_mfma_f32_16x16x32_bf16 v[180:183], v[72:75], v[132:135], v[180:183]
s_waitcnt lgkmcnt(11)
ds_read_b64 v[34:35], v82 offset:584
v_mfma_f32_16x16x32_bf16 v[180:183], v[76:79], v[128:131], v[180:183]
ds_read_b128 v[120:123], v83 offset:3136
v_mfma_f32_16x16x32_bf16 v[184:187], v[40:43], v[152:155], v[184:187]
ds_read_b64 v[36:37], v82 offset:64
v_mfma_f32_16x16x32_bf16 v[184:187], v[44:47], v[148:151], v[184:187]
ds_read_b64 v[38:39], v82 offset:72
v_mfma_f32_16x16x32_bf16 v[184:187], v[48:51], v[144:147], v[184:187]
s_waitcnt lgkmcnt(11)
ds_read_b128 v[124:127], v83 offset:3648
v_mfma_f32_16x16x32_bf16 v[184:187], v[68:71], v[140:143], v[184:187]
buffer_load_dwordx4 v56, s[44:47], s92 offen offset:2048 lds
v_mfma_f32_16x16x32_bf16 v[184:187], v[72:75], v[136:139], v[184:187]
buffer_load_dwordx4 v57, s[44:47], s92 offen offset:3072 lds
v_mfma_f32_16x16x32_bf16 v[184:187], v[76:79], v[132:135], v[184:187]
s_add_u32 m0, s87, 102400
s_add_u32 s92, s92, 32768
buffer_load_dwordx4 v54, s[44:47], s92 offen offset:0 lds
v_mfma_f32_16x16x32_bf16 v[184:187], v[88:91], v[128:131], v[184:187]
buffer_load_dwordx4 v55, s[44:47], s92 offen offset:1024 lds
v_mfma_f32_16x16x32_bf16 v[188:191], v[40:43], v[156:159], v[188:191]
buffer_load_dwordx4 v56, s[44:47], s92 offen offset:2048 lds
v_mfma_f32_16x16x32_bf16 v[188:191], v[44:47], v[152:155], v[188:191]
buffer_load_dwordx4 v57, s[44:47], s92 offen offset:3072 lds
v_mfma_f32_16x16x32_bf16 v[188:191], v[48:51], v[148:151], v[188:191]
v_mfma_f32_16x16x32_bf16 v[188:191], v[68:71], v[144:147], v[188:191]
ds_read_b64_tr_b16 a[128:129], v62 offset:0
ds_read_b64_tr_b16 a[130:131], v62 offset:512
v_mfma_f32_16x16x32_bf16 v[188:191], v[72:75], v[140:143], v[188:191]
ds_read_b64_tr_b16 a[132:133], v63 offset:0
s_waitcnt lgkmcnt(11)
ds_read_b64_tr_b16 a[134:135], v63 offset:512
v_mfma_f32_16x16x32_bf16 v[188:191], v[76:79], v[136:139], v[188:191]
ds_read_b64_tr_b16 a[136:137], v62 offset:2048
ds_read_b64_tr_b16 a[138:139], v62 offset:2560
v_mfma_f32_16x16x32_bf16 v[188:191], v[88:91], v[132:135], v[188:191]
ds_read_b64_tr_b16 a[140:141], v63 offset:2048
s_waitcnt lgkmcnt(11)
ds_read_b64_tr_b16 a[142:143], v63 offset:2560
v_mfma_f32_16x16x32_bf16 v[188:191], v[92:95], v[128:131], v[188:191]
ds_read_b64_tr_b16 a[144:145], v62 offset:4096
ds_read_b64_tr_b16 a[146:147], v62 offset:4608
v_and_b32 v52, 15, v1
v_lshlrev_b32 v52, 3, v52
s_lshr_b32 s57, s84, 1
s_lshl_b32 s57, s57, 7
s_add_u32 s57, s57, 2134016
v_add_u32 v52, s57, v52
buffer_load_dwordx2 v[66:67], v52, s[48:51], 0 offen offset:0 sc1
v_mfma_f32_16x16x32_bf16 v[160:163], v[8:11], v[96:99], v[160:163]
ds_read_b64 v[40:41], v82 offset:3584
v_mfma_f32_16x16x32_bf16 v[164:167], v[8:11], v[100:103], v[164:167]
s_waitcnt lgkmcnt(11)
ds_read_b64 v[42:43], v82 offset:3592
v_mfma_f32_16x16x32_bf16 v[164:167], v[12:15], v[96:99], v[164:167]
ds_read_b128 v[128:131], v83 offset:0
v_mfma_f32_16x16x32_bf16 v[168:171], v[8:11], v[104:107], v[168:171]
ds_read_b64 v[44:45], v82 offset:3072
v_mfma_f32_16x16x32_bf16 v[168:171], v[12:15], v[100:103], v[168:171]
ds_read_b64 v[46:47], v82 offset:3080
v_mfma_f32_16x16x32_bf16 v[168:171], v[16:19], v[96:99], v[168:171]
s_waitcnt lgkmcnt(11)
ds_read_b128 v[132:135], v83 offset:512
v_mfma_f32_16x16x32_bf16 v[172:175], v[8:11], v[108:111], v[172:175]
ds_read_b64 v[48:49], v82 offset:2560
v_mfma_f32_16x16x32_bf16 v[172:175], v[12:15], v[104:107], v[172:175]
ds_read_b64 v[50:51], v82 offset:2568
v_mfma_f32_16x16x32_bf16 v[172:175], v[16:19], v[100:103], v[172:175]
ds_read_b128 v[136:139], v83 offset:1024
v_mfma_f32_16x16x32_bf16 v[172:175], v[20:23], v[96:99], v[172:175]
s_waitcnt lgkmcnt(11)
ds_read_b64 v[68:69], v82 offset:2048
v_mfma_f32_16x16x32_bf16 v[176:179], v[8:11], v[112:115], v[176:179]
ds_read_b64 v[70:71], v82 offset:2056
v_mfma_f32_16x16x32_bf16 v[176:179], v[12:15], v[108:111], v[176:179]
ds_read_b128 v[140:143], v83 offset:1536
v_mfma_f32_16x16x32_bf16 v[176:179], v[16:19], v[104:107], v[176:179]
ds_read_b64 v[72:73], v82 offset:1536
v_mfma_f32_16x16x32_bf16 v[176:179], v[20:23], v[100:103], v[176:179]
s_waitcnt lgkmcnt(11)
ds_read_b64 v[74:75], v82 offset:1544
v_mfma_f32_16x16x32_bf16 v[176:179], v[24:27], v[96:99], v[176:179]
ds_read_b128 v[144:147], v83 offset:2048
v_mfma_f32_16x16x32_bf16 v[180:183], v[8:11], v[116:119], v[180:183]
ds_read_b64 v[76:77], v82 offset:1024
v_mfma_f32_16x16x32_bf16 v[180:183], v[12:15], v[112:115], v[180:183]
ds_read_b64 v[78:79], v82 offset:1032
v_mfma_f32_16x16x32_bf16 v[180:183], v[16:19], v[108:111], v[180:183]
s_waitcnt lgkmcnt(11)
ds_read_b128 v[148:151], v83 offset:2560
v_mfma_f32_16x16x32_bf16 v[180:183], v[20:23], v[104:107], v[180:183]
ds_read_b64 v[88:89], v82 offset:512
v_mfma_f32_16x16x32_bf16 v[180:183], v[24:27], v[100:103], v[180:183]
ds_read_b64 v[90:91], v82 offset:520
v_mfma_f32_16x16x32_bf16 v[180:183], v[28:31], v[96:99], v[180:183]
ds_read_b128 v[152:155], v83 offset:3072
v_mfma_f32_16x16x32_bf16 v[184:187], v[8:11], v[120:123], v[184:187]
s_waitcnt lgkmcnt(11)
ds_read_b64 v[92:93], v82 offset:0
v_mfma_f32_16x16x32_bf16 v[184:187], v[12:15], v[116:119], v[184:187]
ds_read_b64 v[94:95], v82 offset:8
v_mfma_f32_16x16x32_bf16 v[184:187], v[16:19], v[112:115], v[184:187]
ds_read_b128 v[156:159], v83 offset:3584
v_mfma_f32_16x16x32_bf16 v[184:187], v[20:23], v[108:111], v[184:187]
ds_read_b64_tr_b16 a[148:149], v63 offset:4096
s_waitcnt lgkmcnt(11)
ds_read_b64_tr_b16 a[150:151], v63 offset:4608
v_mfma_f32_16x16x32_bf16 v[184:187], v[24:27], v[104:107], v[184:187]
ds_read_b64_tr_b16 a[152:153], v62 offset:6144
ds_read_b64_tr_b16 a[154:155], v62 offset:6656
v_mfma_f32_16x16x32_bf16 v[184:187], v[28:31], v[100:103], v[184:187]
ds_read_b64_tr_b16 a[156:157], v63 offset:6144
s_waitcnt lgkmcnt(11)
ds_read_b64_tr_b16 a[158:159], v63 offset:6656
v_mfma_f32_16x16x32_bf16 v[184:187], v[32:35], v[96:99], v[184:187]
s_waitcnt lgkmcnt(0)
v_mfma_f32_16x16x32_bf16 v[188:191], v[8:11], v[124:127], v[188:191]
s_add_u32 s92, s89, 6
s_sub_u32 s67, s92, 7
s_cmp_ge_u32 s92, 7
s_cselect_b32 s92, s67, s92
s_add_u32 m0, s87, 131072
s_lshl_b32 s92, s92, 16
s_add_u32 s92, s92, s86
buffer_load_dwordx4 v54, s[44:47], s92 offen offset:0 lds
v_mfma_f32_16x16x32_bf16 v[188:191], v[12:15], v[120:123], v[188:191]
buffer_load_dwordx4 v55, s[44:47], s92 offen offset:1024 lds
v_mfma_f32_16x16x32_bf16 v[188:191], v[16:19], v[116:119], v[188:191]
buffer_load_dwordx4 v56, s[44:47], s92 offen offset:2048 lds
v_mfma_f32_16x16x32_bf16 v[188:191], v[20:23], v[112:115], v[188:191]
buffer_load_dwordx4 v57, s[44:47], s92 offen offset:3072 lds
v_mfma_f32_16x16x32_bf16 v[188:191], v[24:27], v[108:111], v[188:191]
s_add_u32 m0, s87, 135168
s_add_u32 s92, s92, 32768
buffer_load_dwordx4 v54, s[44:47], s92 offen offset:0 lds
v_mfma_f32_16x16x32_bf16 v[188:191], v[28:31], v[104:107], v[188:191]
buffer_load_dwordx4 v55, s[44:47], s92 offen offset:1024 lds
v_mfma_f32_16x16x32_bf16 v[188:191], v[32:35], v[100:103], v[188:191]
buffer_load_dwordx4 v56, s[44:47], s92 offen offset:2048 lds
v_mfma_f32_16x16x32_bf16 v[188:191], v[36:39], v[96:99], v[188:191]
buffer_load_dwordx4 v57, s[44:47], s92 offen offset:3072 lds
s_lshl_b32 s7, s54, 12
s_add_u32 s7, s7, 52736
v_add_u32 v5, s7, v2
s_xor_b32 s7, s54, 1
s_lshl_b32 s7, s7, 12
s_add_u32 s7, s7, 52736
v_add_u32 v6, s7, v2
s_mul_i32 s7, s81, 4608
s_lshl_b32 s8, s82, 11
s_add_u32 s7, s7, s8
s_add_u32 s7, s7, 44032
v_add_u32 v7, s7, v84
s_lshl_b32 s6, s83, 12
s_add_u32 s6, s6, s8
s_add_u32 s6, s6, 3145728
s_waitcnt vmcnt(8)
v_cmp_eq_u64 vcc, s[58:59], v[66:67]
s_cmp_eq_u64 vcc, exec
s_cbranch_scc0 L_pp_10
L_pd_11:
s_lshl_b32 s57, s84, 1
s_and_b32 s60, s54, 1
s_add_u32 s61, s57, s60
s_xor_b32 s60, s60, 1
s_add_u32 s62, s57, s60
s_mul_i32 s61, s61, 112
s_mul_i32 s62, s62, 112
s_mul_i32 s57, s54, 28
s_add_u32 s61, s61, s57
s_add_u32 s62, s62, s57
s_lshl_b32 s61, s61, 10
s_lshl_b32 s62, s62, 10
s_add_u32 s7, s61, 5242880
s_add_u32 s8, s62, 5242880
v_mfma_f32_16x16x32_bf16 v[160:163], v[40:43], v[128:131], v[160:163]
v_mfma_f32_16x16x32_bf16 v[164:167], v[40:43], v[132:135], v[164:167]
v_mfma_f32_16x16x32_bf16 v[164:167], v[44:47], v[128:131], v[164:167]
v_mfma_f32_16x16x32_bf16 v[168:171], v[40:43], v[136:139], v[168:171]
s_mov_b32 s9, s89
s_lshl_b32 s10, s9, 12
s_add_u32 s11, s10, s8
s_add_u32 s10, s10, s7
buffer_load_dwordx4 v[8:11], v2, s[48:51], s10 offen offset:0 sc1
v_mfma_f32_16x16x32_bf16 v[168:171], v[44:47], v[132:135], v[168:171]
v_mfma_f32_16x16x32_bf16 v[168:171], v[48:51], v[128:131], v[168:171]
v_mfma_f32_16x16x32_bf16 v[172:175], v[40:43], v[140:143], v[172:175]
v_mfma_f32_16x16x32_bf16 v[172:175], v[44:47], v[136:139], v[172:175]
buffer_load_dwordx4 v[12:15], v2, s[48:51], s11 offen offset:0 sc1
v_mfma_f32_16x16x32_bf16 v[172:175], v[48:51], v[132:135], v[172:175]
v_mfma_f32_16x16x32_bf16 v[172:175], v[68:71], v[128:131], v[172:175]
v_mfma_f32_16x16x32_bf16 v[176:179], v[40:43], v[144:147], v[176:179]
v_mfma_f32_16x16x32_bf16 v[176:179], v[44:47], v[140:143], v[176:179]
buffer_load_dwordx4 v[16:19], v2, s[48:51], s10 offen offset:1024 sc1
v_mfma_f32_16x16x32_bf16 v[176:179], v[48:51], v[136:139], v[176:179]
v_mfma_f32_16x16x32_bf16 v[176:179], v[68:71], v[132:135], v[176:179]
v_mfma_f32_16x16x32_bf16 v[176:179], v[72:75], v[128:131], v[176:179]
v_mfma_f32_16x16x32_bf16 v[180:183], v[40:43], v[148:151], v[180:183]
buffer_load_dwordx4 v[20:23], v2, s[48:51], s11 offen offset:1024 sc1
v_mfma_f32_16x16x32_bf16 v[180:183], v[44:47], v[144:147], v[180:183]
v_mfma_f32_16x16x32_bf16 v[180:183], v[48:51], v[140:143], v[180:183]
v_mfma_f32_16x16x32_bf16 v[180:183], v[68:71], v[136:139], v[180:183]
v_mfma_f32_16x16x32_bf16 v[180:183], v[72:75], v[132:135], v[180:183]
buffer_load_dwordx4 v[24:27], v2, s[48:51], s10 offen offset:2048 sc1
v_mfma_f32_16x16x32_bf16 v[180:183], v[76:79], v[128:131], v[180:183]
v_mfma_f32_16x16x32_bf16 v[184:187], v[40:43], v[152:155], v[184:187]
v_mfma_f32_16x16x32_bf16 v[184:187], v[44:47], v[148:151], v[184:187]
v_mfma_f32_16x16x32_bf16 v[184:187], v[48:51], v[144:147], v[184:187]
buffer_load_dwordx4 v[28:31], v2, s[48:51], s11 offen offset:2048 sc1
v_mfma_f32_16x16x32_bf16 v[184:187], v[68:71], v[140:143], v[184:187]
v_mfma_f32_16x16x32_bf16 v[184:187], v[72:75], v[136:139], v[184:187]
v_mfma_f32_16x16x32_bf16 v[184:187], v[76:79], v[132:135], v[184:187]
v_mfma_f32_16x16x32_bf16 v[184:187], v[88:91], v[128:131], v[184:187]
buffer_load_dwordx4 v[32:35], v2, s[48:51], s10 offen offset:3072 sc1
v_mfma_f32_16x16x32_bf16 v[188:191], v[40:43], v[156:159], v[188:191]
v_mfma_f32_16x16x32_bf16 v[188:191], v[44:47], v[152:155], v[188:191]
v_mfma_f32_16x16x32_bf16 v[188:191], v[48:51], v[148:151], v[188:191]
v_mfma_f32_16x16x32_bf16 v[188:191], v[68:71], v[144:147], v[188:191]
buffer_load_dwordx4 v[36:39], v2, s[48:51], s11 offen offset:3072 sc1
v_mfma_f32_16x16x32_bf16 v[188:191], v[72:75], v[140:143], v[188:191]
v_mfma_f32_16x16x32_bf16 v[188:191], v[76:79], v[136:139], v[188:191]
v_mfma_f32_16x16x32_bf16 v[188:191], v[88:91], v[132:135], v[188:191]
v_mfma_f32_16x16x32_bf16 v[188:191], v[92:95], v[128:131], v[188:191]
s_add_u32 s9, s9, 1
s_cmp_eq_u32 s9, 7
s_cselect_b32 s9, 0, s9
s_lshl_b32 s10, s9, 12
s_add_u32 s11, s10, s8
s_add_u32 s10, s10, s7
buffer_load_dwordx4 v[52:55], v2, s[48:51], s10 offen offset:0 sc1
s_cmp_eq_u32 s82, 0
s_cselect_b64 exec, 0, -1
v_swap_b32 v160, v176
v_swap_b32 v161, v177
v_swap_b32 v162, v178
v_swap_b32 v163, v179
v_swap_b32 v164, v180
v_swap_b32 v165, v181
v_swap_b32 v166, v182
v_swap_b32 v167, v183
v_swap_b32 v168, v184
v_swap_b32 v169, v185
v_swap_b32 v170, v186
v_swap_b32 v171, v187
v_swap_b32 v172, v188
v_swap_b32 v173, v189
v_swap_b32 v174, v190
v_swap_b32 v175, v191
s_mov_b64 exec, -1
ds_write_b128 v5, v[176:179] offset:0
ds_write_b128 v5, v[180:183] offset:1024
ds_write_b128 v5, v[184:187] offset:2048
ds_write_b128 v5, v[188:191] offset:3072
ds_read_b64 v[40:41], v7 offset:0
ds_read_b64 v[42:43], v7 offset:512
ds_read_b64 v[44:45], v7 offset:1024
ds_read_b64 v[46:47], v7 offset:1536
buffer_load_dwordx4 v[96:99], v2, s[48:51], s11 offen offset:0 sc1
buffer_load_dwordx4 v[100:103], v2, s[48:51], s10 offen offset:1024 sc1
buffer_load_dwordx4 v[104:107], v2, s[48:51], s11 offen offset:1024 sc1
buffer_load_dwordx4 v[108:111], v2, s[48:51], s10 offen offset:2048 sc1
s_waitcnt lgkmcnt(0)
s_barrier
ds_read_b128 v[48:51], v6 offset:0
ds_read_b128 v[68:71], v6 offset:1024
ds_read_b128 v[72:75], v6 offset:2048
ds_read_b128 v[76:79], v6 offset:3072
buffer_load_dwordx4 v[112:115], v2, s[48:51], s11 offen offset:2048 sc1
buffer_load_dwordx4 v[116:119], v2, s[48:51], s10 offen offset:3072 sc1
buffer_load_dwordx4 v[120:123], v2, s[48:51], s11 offen offset:3072 sc1
s_waitcnt lgkmcnt(0)
v_mov_b32 v90, v65
v_pk_add_f32 v[160:161], v[160:161], v[48:49]
v_pk_add_f32 v[162:163], v[162:163], v[50:51]
v_lshlrev_b32 v86, 16, v40
v_and_b32 v87, 0xffff0000, v40
v_lshlrev_b32 v88, 16, v41
v_and_b32 v89, 0xffff0000, v41
v_pk_fma_f32 v[160:161], v[86:87], v[90:91], v[160:161] op_sel_hi:[1,0,1]
v_pk_fma_f32 v[162:163], v[88:89], v[90:91], v[162:163] op_sel_hi:[1,0,1]
v_cvt_pk_bf16_f32 v66, v160, v161
v_cvt_pk_bf16_f32 v67, v162, v163
v_min_u32 v66, -2, v66
v_min_u32 v67, -2, v67
buffer_store_dwordx2 v[66:67], v84, s[48:51], s6 offen offset:0 sc1
v_pk_add_f32 v[164:165], v[164:165], v[68:69]
v_pk_add_f32 v[166:167], v[166:167], v[70:71]
v_lshlrev_b32 v86, 16, v42
v_and_b32 v87, 0xffff0000, v42
v_lshlrev_b32 v88, 16, v43
v_and_b32 v89, 0xffff0000, v43
v_pk_fma_f32 v[164:165], v[86:87], v[90:91], v[164:165] op_sel_hi:[1,0,1]
v_pk_fma_f32 v[166:167], v[88:89], v[90:91], v[166:167] op_sel_hi:[1,0,1]
v_cvt_pk_bf16_f32 v80, v164, v165
v_cvt_pk_bf16_f32 v81, v166, v167
v_min_u32 v80, -2, v80
v_min_u32 v81, -2, v81
buffer_store_dwordx2 v[80:81], v84, s[48:51], s6 offen offset:512 sc1
v_pk_add_f32 v[168:169], v[168:169], v[72:73]
v_pk_add_f32 v[170:171], v[170:171], v[74:75]
v_lshlrev_b32 v86, 16, v44
v_and_b32 v87, 0xffff0000, v44
v_lshlrev_b32 v88, 16, v45
v_and_b32 v89, 0xffff0000, v45
v_pk_fma_f32 v[168:169], v[86:87], v[90:91], v[168:169] op_sel_hi:[1,0,1]
v_pk_fma_f32 v[170:171], v[88:89], v[90:91], v[170:171] op_sel_hi:[1,0,1]
v_cvt_pk_bf16_f32 v66, v168, v169
v_cvt_pk_bf16_f32 v67, v170, v171
v_min_u32 v66, -2, v66
v_min_u32 v67, -2, v67
buffer_store_dwordx2 v[66:67], v84, s[48:51], s6 offen offset:1024 sc1
v_pk_add_f32 v[172:173], v[172:173], v[76:77]
v_pk_add_f32 v[174:175], v[174:175], v[78:79]
v_lshlrev_b32 v86, 16, v46
v_and_b32 v87, 0xffff0000, v46
v_lshlrev_b32 v88, 16, v47
v_and_b32 v89, 0xffff0000, v47
v_pk_fma_f32 v[172:173], v[86:87], v[90:91], v[172:173] op_sel_hi:[1,0,1]
v_pk_fma_f32 v[174:175], v[88:89], v[90:91], v[174:175] op_sel_hi:[1,0,1]
v_cvt_pk_bf16_f32 v80, v172, v173
v_cvt_pk_bf16_f32 v81, v174, v175
v_min_u32 v80, -2, v80
v_min_u32 v81, -2, v81
buffer_store_dwordx2 v[80:81], v84, s[48:51], s6 offen offset:1536 sc1
s_waitcnt lgkmcnt(0)
s_barrier
s_waitcnt vmcnt(18)
v_mfma_f32_32x32x16_bf16 v[68:83], a[0:3], v[8:11], 0
s_mov_b32 s16, s28
s_and_b32 s17, s29, 0xffff
s_mov_b32 s18, 2097152
v_mfma_f32_32x32x16_bf16 v[144:159], a[4:7], v[8:11], 0
s_add_u32 s9, s9, 1
s_cmp_eq_u32 s9, 7
s_cselect_b32 s9, 0, s9
s_lshl_b32 s10, s9, 12
s_add_u32 s11, s10, s8
s_add_u32 s10, s10, s7
buffer_load_dwordx4 v[8:11], v2, s[48:51], s10 offen offset:0 sc1
s_mov_b32 s19, 0x20000
v_lshrrev_b32 v5, 3, v1
v_lshlrev_b32 v5, 7, v5
v_mfma_f32_32x32x16_bf16 v[128:143], a[0:3], v[12:15], 0
v_lshrrev_b32 v6, 4, v1
v_and_b32 v4, 7, v1
v_xor_b32 v6, v6, v4
v_mfma_f32_32x32x16_bf16 v[160:175], a[4:7], v[12:15], 0
buffer_load_dwordx4 v[12:15], v2, s[48:51], s11 offen offset:0 sc1
v_lshlrev_b32 v6, 4, v6
s_lshl_b32 s67, s54, 11
s_add_u32 s67, s67, 49152
s_waitcnt vmcnt(18)
v_mfma_f32_32x32x16_bf16 v[68:83], a[8:11], v[16:19], v[68:83]
v_add3_u32 v3, v5, v6, s67
v_xor_b32 v4, 64, v3
v_add_u32 v4, 1024, v4
v_mfma_f32_32x32x16_bf16 v[144:159], a[12:15], v[16:19], v[144:159]
buffer_load_dwordx4 v[16:19], v2, s[48:51], s10 offen offset:1024 sc1
v_lshrrev_b32 v6, 4, v1
v_and_b32 v6, 1, v6
v_lshlrev_b32 v6, 2, v6
v_mfma_f32_32x32x16_bf16 v[128:143], a[8:11], v[20:23], v[128:143]
v_and_b32 v7, 7, v1
v_xor_b32 v6, v6, v7
v_lshlrev_b32 v6, 4, v6
v_mfma_f32_32x32x16_bf16 v[160:175], a[12:15], v[20:23], v[160:175]
buffer_load_dwordx4 v[20:23], v2, s[48:51], s11 offen offset:1024 sc1
s_lshl_b32 s67, s54, 11
s_add_u32 s67, s67, 57344
v_add3_u32 v7, v5, v6, s67
v_lshrrev_b32 v56, 3, v1
v_lshlrev_b32 v57, 12, v56
v_lshlrev_b32 v56, 10, v56
v_and_b32 v64, 7, v1
v_lshlrev_b32 v64, 4, v64
v_add_u32 v56, v56, v64
v_add_u32 v57, v57, v64
s_lshl_b32 s12, s84, 16
s_lshl_b32 s57, s54, 14
s_add_u32 s12, s12, s57
s_lshl_b32 s57, s85, 7
s_add_u32 s12, s12, s57
s_add_u32 s57, s12, 8192
buffer_load_dwordx4 v[124:127], v56, s[36:39], s12 offen
buffer_load_dwordx4 v[192:195], v56, s[36:39], s57 offen
s_waitcnt vmcnt(20)
v_mfma_f32_32x32x16_bf16 v[68:83], a[16:19], v[24:27], v[68:83]
v_and_b32 v49, 31, v1
v_lshlrev_b32 v49, 4, v49
s_lshl_b32 s67, s84, 10
v_mfma_f32_32x32x16_bf16 v[144:159], a[20:23], v[24:27], v[144:159]
buffer_load_dwordx4 v[24:27], v2, s[48:51], s10 offen offset:2048 sc1
s_and_b32 s68, s54, 1
s_lshl_b32 s68, s68, 9
s_add_u32 s67, s67, s68
v_mfma_f32_32x32x16_bf16 v[128:143], a[16:19], v[28:31], v[128:143]
s_add_u32 s67, s67, 2097152
v_add_u32 v49, s67, v49
v_mfma_f32_32x32x16_bf16 v[160:175], a[20:23], v[28:31], v[160:175]
buffer_load_dwordx4 v[28:31], v2, s[48:51], s11 offen offset:2048 sc1
s_xor_b32 s67, s54, 1
s_mul_i32 s67, s67, 12288
s_add_u32 s67, s67, 0
s_waitcnt vmcnt(20)
v_mfma_f32_32x32x16_bf16 v[68:83], a[24:27], v[32:35], v[68:83]
v_add_u32 v41, s67, v2
s_xor_b32 s67, s54, 2
s_mul_i32 s67, s67, 12288
v_mfma_f32_32x32x16_bf16 v[144:159], a[28:31], v[32:35], v[144:159]
buffer_load_dwordx4 v[32:35], v2, s[48:51], s10 offen offset:3072 sc1
s_add_u32 s67, s67, 4096
v_add_u32 v42, s67, v2
s_xor_b32 s67, s54, 3
v_mfma_f32_32x32x16_bf16 v[128:143], a[24:27], v[36:39], v[128:143]
s_mul_i32 s67, s67, 12288
s_add_u32 s67, s67, 8192
v_add_u32 v43, s67, v2
v_mfma_f32_32x32x16_bf16 v[160:175], a[28:31], v[36:39], v[160:175]
buffer_load_dwordx4 v[36:39], v2, s[48:51], s11 offen offset:3072 sc1
v_lshrrev_b32 v5, 5, v1
v_lshlrev_b32 v5, 2, v5
v_lshrrev_b32 v6, 2, v1
s_waitcnt vmcnt(20)
v_mfma_f32_32x32x16_bf16 v[68:83], a[32:35], v[52:55], v[68:83]
v_and_b32 v6, 3, v6
v_add_u32 v5, v5, v6
v_lshlrev_b32 v44, 7, v5
v_mfma_f32_32x32x16_bf16 v[144:159], a[36:39], v[52:55], v[144:159]
s_add_u32 s9, s9, 1
s_cmp_eq_u32 s9, 7
s_cselect_b32 s9, 0, s9
s_lshl_b32 s10, s9, 12
s_add_u32 s11, s10, s8
s_add_u32 s10, s10, s7
buffer_load_dwordx4 v[52:55], v2, s[48:51], s10 offen offset:0 sc1
v_lshrrev_b32 v6, 1, v6
s_and_b32 s67, s54, 1
v_xor_b32 v6, s67, v6
v_mfma_f32_32x32x16_bf16 v[128:143], a[32:35], v[96:99], v[128:143]
v_lshlrev_b32 v6, 6, v6
v_add_u32 v44, v44, v6
v_lshrrev_b32 v6, 4, v1
v_mfma_f32_32x32x16_bf16 v[160:175], a[36:39], v[96:99], v[160:175]
buffer_load_dwordx4 v[96:99], v2, s[48:51], s11 offen offset:0 sc1
v_and_b32 v6, 1, v6
v_lshlrev_b32 v6, 5, v6
v_add_u32 v44, v44, v6
s_waitcnt vmcnt(20)
v_mfma_f32_32x32x16_bf16 v[68:83], a[40:43], v[100:103], v[68:83]
v_and_b32 v6, 3, v1
v_lshlrev_b32 v6, 3, v6
v_add_u32 v44, v44, v6
v_mfma_f32_32x32x16_bf16 v[144:159], a[44:47], v[100:103], v[144:159]
buffer_load_dwordx4 v[100:103], v2, s[48:51], s10 offen offset:1024 sc1
s_lshr_b32 s68, s54, 1
s_lshl_b32 s68, s68, 12
s_add_u32 s68, s68, 57344
v_mfma_f32_32x32x16_bf16 v[128:143], a[40:43], v[104:107], v[128:143]
v_add_u32 v44, s68, v44
v_and_b32 v5, 31, v1
v_lshrrev_b32 v6, 1, v5
v_mfma_f32_32x32x16_bf16 v[160:175], a[44:47], v[104:107], v[160:175]
buffer_load_dwordx4 v[104:107], v2, s[48:51], s11 offen offset:1024 sc1
v_and_b32 v6, 7, v6
s_lshr_b32 s68, s54, 1
s_lshl_b32 s68, s68, 2
s_waitcnt vmcnt(20)
v_mfma_f32_32x32x16_bf16 v[68:83], a[48:51], v[108:111], v[68:83]
v_xor_b32 v6, s68, v6
v_lshlrev_b32 v6, 4, v6
v_lshlrev_b32 v5, 7, v5
v_mfma_f32_32x32x16_bf16 v[144:159], a[52:55], v[108:111], v[144:159]
buffer_load_dwordx4 v[108:111], v2, s[48:51], s10 offen offset:2048 sc1
v_add_u32 v45, v5, v6
v_lshrrev_b32 v5, 5, v1
v_lshlrev_b32 v5, 3, v5
v_mfma_f32_32x32x16_bf16 v[128:143], a[48:51], v[112:115], v[128:143]
v_add_u32 v45, v45, v5
s_and_b32 s67, s54, 1
s_lshl_b32 s67, s67, 12
v_mfma_f32_32x32x16_bf16 v[160:175], a[52:55], v[112:115], v[160:175]
buffer_load_dwordx4 v[112:115], v2, s[48:51], s11 offen offset:2048 sc1
s_add_u32 s67, s67, 49152
v_add_u32 v45, s67, v45
v_xor_b32 v46, 16, v45
s_waitcnt vmcnt(20)
v_mfma_f32_32x32x16_bf16 v[68:83], a[56:59], v[116:119], v[68:83]
v_xor_b32 v47, 32, v45
v_xor_b32 v48, 48, v45
s_mul_i32 s67, s54, 12288
v_mfma_f32_32x32x16_bf16 v[144:159], a[60:63], v[116:119], v[144:159]
buffer_load_dwordx4 v[116:119], v2, s[48:51], s10 offen offset:3072 sc1
s_add_u32 s67, s67, 0
v_add_u32 v40, s67, v2
s_lshl_b32 s13, s85, 18
v_mfma_f32_32x32x16_bf16 v[128:143], a[56:59], v[120:123], v[128:143]
s_lshl_b32 s67, s54, 16
s_add_u32 s13, s13, s67
s_lshl_b32 s67, s84, 7
v_mfma_f32_32x32x16_bf16 v[160:175], a[60:63], v[120:123], v[160:175]
buffer_load_dwordx4 v[120:123], v2, s[48:51], s11 offen offset:3072 sc1
s_add_u32 s13, s13, s67
s_add_u32 s13, s13, 3145728
s_add_u32 s14, s13, 32768
s_waitcnt vmcnt(16)
v_mfma_f32_32x32x16_bf16 v[68:83], a[64:67], v[8:11], v[68:83]
v_mfma_f32_32x32x16_bf16 v[144:159], a[68:71], v[8:11], v[144:159]
s_add_u32 s9, s9, 1
s_cmp_eq_u32 s9, 7
s_cselect_b32 s9, 0, s9
s_lshl_b32 s10, s9, 12
s_add_u32 s11, s10, s8
s_add_u32 s10, s10, s7
buffer_load_dwordx4 v[8:11], v2, s[48:51], s10 offen offset:0 sc1
v_mfma_f32_32x32x16_bf16 v[128:143], a[64:67], v[12:15], v[128:143]
v_mfma_f32_32x32x16_bf16 v[160:175], a[68:71], v[12:15], v[160:175]
buffer_load_dwordx4 v[12:15], v2, s[48:51], s11 offen offset:0 sc1
s_waitcnt vmcnt(16)
v_mfma_f32_32x32x16_bf16 v[68:83], a[72:75], v[16:19], v[68:83]
v_mfma_f32_32x32x16_bf16 v[144:159], a[76:79], v[16:19], v[144:159]
buffer_load_dwordx4 v[16:19], v2, s[48:51], s10 offen offset:1024 sc1
v_mfma_f32_32x32x16_bf16 v[128:143], a[72:75], v[20:23], v[128:143]
v_mfma_f32_32x32x16_bf16 v[160:175], a[76:79], v[20:23], v[160:175]
buffer_load_dwordx4 v[20:23], v2, s[48:51], s11 offen offset:1024 sc1
s_waitcnt vmcnt(16)
ds_write_b128 v3, v[124:127]
ds_write_b128 v4, v[192:195]
buffer_load_dwordx4 v[84:87], v49, s[48:51], 0 offen sc1
s_waitcnt vmcnt(15)
v_mfma_f32_32x32x16_bf16 v[68:83], a[80:83], v[24:27], v[68:83]
v_mfma_f32_32x32x16_bf16 v[144:159], a[84:87], v[24:27], v[144:159]
buffer_load_dwordx4 v[24:27], v2, s[48:51], s10 offen offset:2048 sc1
v_mfma_f32_32x32x16_bf16 v[128:143], a[80:83], v[28:31], v[128:143]
v_mfma_f32_32x32x16_bf16 v[160:175], a[84:87], v[28:31], v[160:175]
buffer_load_dwordx4 v[28:31], v2, s[48:51], s11 offen offset:2048 sc1
s_waitcnt vmcnt(15)
v_mfma_f32_32x32x16_bf16 v[68:83], a[88:91], v[32:35], v[68:83]
v_mfma_f32_32x32x16_bf16 v[144:159], a[92:95], v[32:35], v[144:159]
buffer_load_dwordx4 v[32:35], v2, s[48:51], s10 offen offset:3072 sc1
v_mfma_f32_32x32x16_bf16 v[128:143], a[88:91], v[36:39], v[128:143]
v_mfma_f32_32x32x16_bf16 v[160:175], a[92:95], v[36:39], v[160:175]
buffer_load_dwordx4 v[36:39], v2, s[48:51], s11 offen offset:3072 sc1
s_waitcnt vmcnt(15)
v_mfma_f32_32x32x16_bf16 v[68:83], a[96:99], v[52:55], v[68:83]
v_mfma_f32_32x32x16_bf16 v[144:159], a[100:103], v[52:55], v[144:159]
s_add_u32 s9, s9, 1
s_cmp_eq_u32 s9, 7
s_cselect_b32 s9, 0, s9
s_lshl_b32 s10, s9, 12
s_add_u32 s11, s10, s8
s_add_u32 s10, s10, s7
buffer_load_dwordx4 v[52:55], v2, s[48:51], s10 offen offset:0 sc1
v_mfma_f32_32x32x16_bf16 v[128:143], a[96:99], v[96:99], v[128:143]
v_mfma_f32_32x32x16_bf16 v[160:175], a[100:103], v[96:99], v[160:175]
buffer_load_dwordx4 v[96:99], v2, s[48:51], s11 offen offset:0 sc1
ds_read_b64_tr_b16 a[160:161], v60 offset:32768
ds_read_b64_tr_b16 a[162:163], v60 offset:33280
ds_read_b64_tr_b16 a[164:165], v61 offset:32768
ds_read_b64_tr_b16 a[166:167], v61 offset:33280
ds_read_b64_tr_b16 a[168:169], v60 offset:34816
ds_read_b64_tr_b16 a[170:171], v60 offset:35328
ds_read_b64_tr_b16 a[172:173], v61 offset:34816
ds_read_b64_tr_b16 a[174:175], v61 offset:35328
s_waitcnt vmcnt(15)
v_mfma_f32_32x32x16_bf16 v[68:83], a[104:107], v[100:103], v[68:83]
v_mfma_f32_32x32x16_bf16 v[144:159], a[108:111], v[100:103], v[144:159]
buffer_load_dwordx4 v[100:103], v2, s[48:51], s10 offen offset:1024 sc1
v_mfma_f32_32x32x16_bf16 v[128:143], a[104:107], v[104:107], v[128:143]
v_mfma_f32_32x32x16_bf16 v[160:175], a[108:111], v[104:107], v[160:175]
buffer_load_dwordx4 v[104:107], v2, s[48:51], s11 offen offset:1024 sc1
ds_read_b64_tr_b16 a[176:177], v60 offset:36864
ds_read_b64_tr_b16 a[178:179], v60 offset:37376
ds_read_b64_tr_b16 a[180:181], v61 offset:36864
ds_read_b64_tr_b16 a[182:183], v61 offset:37376
ds_read_b64_tr_b16 a[184:185], v60 offset:38912
s_waitcnt lgkmcnt(11)
ds_read_b64_tr_b16 a[186:187], v60 offset:39424
ds_read_b64_tr_b16 a[188:189], v61 offset:38912
ds_read_b64_tr_b16 a[190:191], v61 offset:39424
s_waitcnt vmcnt(15)
v_mfma_f32_32x32x16_bf16 v[68:83], a[112:115], v[108:111], v[68:83]
v_mfma_f32_32x32x16_bf16 v[144:159], a[116:119], v[108:111], v[144:159]
buffer_load_dwordx4 v[108:111], v2, s[48:51], s10 offen offset:2048 sc1
v_mfma_f32_32x32x16_bf16 v[128:143], a[112:115], v[112:115], v[128:143]
v_mfma_f32_32x32x16_bf16 v[160:175], a[116:119], v[112:115], v[160:175]
buffer_load_dwordx4 v[112:115], v2, s[48:51], s11 offen offset:2048 sc1
s_waitcnt vmcnt(15)
v_mfma_f32_32x32x16_bf16 v[68:83], a[120:123], v[116:119], v[68:83]
v_mfma_f32_32x32x16_bf16 v[144:159], a[124:127], v[116:119], v[144:159]
buffer_load_dwordx4 v[116:119], v2, s[48:51], s10 offen offset:3072 sc1
v_mfma_f32_32x32x16_bf16 v[128:143], a[120:123], v[120:123], v[128:143]
v_mfma_f32_32x32x16_bf16 v[160:175], a[124:127], v[120:123], v[160:175]
buffer_load_dwordx4 v[120:123], v2, s[48:51], s11 offen offset:3072 sc1
ds_read_b64_tr_b16 a[192:193], v62 offset:0
s_waitcnt lgkmcnt(11)
ds_read_b64_tr_b16 a[194:195], v62 offset:512
ds_read_b64_tr_b16 a[196:197], v63 offset:0
ds_read_b64_tr_b16 a[198:199], v63 offset:512
ds_read_b64_tr_b16 a[200:201], v62 offset:2048
s_waitcnt lgkmcnt(11)
ds_read_b64_tr_b16 a[202:203], v62 offset:2560
ds_read_b64_tr_b16 a[204:205], v63 offset:2048
ds_read_b64_tr_b16 a[206:207], v63 offset:2560
s_waitcnt vmcnt(15)
v_mfma_f32_32x32x16_bf16 v[68:83], a[128:131], v[8:11], v[68:83]
v_mfma_f32_32x32x16_bf16 v[144:159], a[132:135], v[8:11], v[144:159]
s_add_u32 s9, s9, 1
s_cmp_eq_u32 s9, 7
s_cselect_b32 s9, 0, s9
s_lshl_b32 s10, s9, 12
s_add_u32 s11, s10, s8
s_add_u32 s10, s10, s7
buffer_load_dwordx4 v[8:11], v2, s[48:51], s10 offen offset:0 sc1
v_mfma_f32_32x32x16_bf16 v[128:143], a[128:131], v[12:15], v[128:143]
v_mfma_f32_32x32x16_bf16 v[160:175], a[132:135], v[12:15], v[160:175]
buffer_load_dwordx4 v[12:15], v2, s[48:51], s11 offen offset:0 sc1
ds_read_b64_tr_b16 a[208:209], v62 offset:4096
s_waitcnt lgkmcnt(11)
ds_read_b64_tr_b16 a[210:211], v62 offset:4608
ds_read_b64_tr_b16 a[212:213], v63 offset:4096
ds_read_b64_tr_b16 a[214:215], v63 offset:4608
ds_read_b64_tr_b16 a[216:217], v62 offset:6144
s_waitcnt lgkmcnt(11)
ds_read_b64_tr_b16 a[218:219], v62 offset:6656
ds_read_b64_tr_b16 a[220:221], v63 offset:6144
ds_read_b64_tr_b16 a[222:223], v63 offset:6656
s_waitcnt vmcnt(15)
v_mfma_f32_32x32x16_bf16 v[68:83], a[136:139], v[16:19], v[68:83]
v_mfma_f32_32x32x16_bf16 v[144:159], a[140:143], v[16:19], v[144:159]
buffer_load_dwordx4 v[16:19], v2, s[48:51], s10 offen offset:1024 sc1
v_mfma_f32_32x32x16_bf16 v[128:143], a[136:139], v[20:23], v[128:143]
v_mfma_f32_32x32x16_bf16 v[160:175], a[140:143], v[20:23], v[160:175]
buffer_load_dwordx4 v[20:23], v2, s[48:51], s11 offen offset:1024 sc1
s_waitcnt lgkmcnt(0)
s_waitcnt vmcnt(14)
v_mfma_f32_32x32x16_bf16 v[68:83], a[144:147], v[24:27], v[68:83]
v_mfma_f32_32x32x16_bf16 v[144:159], a[148:151], v[24:27], v[144:159]
buffer_load_dwordx4 v[24:27], v2, s[48:51], s10 offen offset:2048 sc1
v_mfma_f32_32x32x16_bf16 v[128:143], a[144:147], v[28:31], v[128:143]
v_mfma_f32_32x32x16_bf16 v[160:175], a[148:151], v[28:31], v[160:175]
buffer_load_dwordx4 v[28:31], v2, s[48:51], s11 offen offset:2048 sc1
s_waitcnt vmcnt(14)
v_mfma_f32_32x32x16_bf16 v[68:83], a[152:155], v[32:35], v[68:83]
v_mfma_f32_32x32x16_bf16 v[144:159], a[156:159], v[32:35], v[144:159]
buffer_load_dwordx4 v[32:35], v2, s[48:51], s10 offen offset:3072 sc1
v_mfma_f32_32x32x16_bf16 v[128:143], a[152:155], v[36:39], v[128:143]
v_mfma_f32_32x32x16_bf16 v[160:175], a[156:159], v[36:39], v[160:175]
buffer_load_dwordx4 v[36:39], v2, s[48:51], s11 offen offset:3072 sc1
s_waitcnt vmcnt(14)
v_mfma_f32_32x32x16_bf16 v[68:83], a[160:163], v[52:55], v[68:83]
v_mfma_f32_32x32x16_bf16 v[144:159], a[164:167], v[52:55], v[144:159]
v_mfma_f32_32x32x16_bf16 v[128:143], a[160:163], v[96:99], v[128:143]
v_mfma_f32_32x32x16_bf16 v[160:175], a[164:167], v[96:99], v[160:175]
s_waitcnt lgkmcnt(0)
buffer_load_dwordx4 v[124:127], v57, s[48:51], s13 offen sc1
buffer_load_dwordx4 v[192:195], v57, s[48:51], s14 offen sc1
s_waitcnt vmcnt(14)
v_mfma_f32_32x32x16_bf16 v[68:83], a[168:171], v[100:103], v[68:83]
v_mfma_f32_32x32x16_bf16 v[144:159], a[172:175], v[100:103], v[144:159]
v_mfma_f32_32x32x16_bf16 v[128:143], a[168:171], v[104:107], v[128:143]
v_mfma_f32_32x32x16_bf16 v[160:175], a[172:175], v[104:107], v[160:175]
s_waitcnt vmcnt(12)
v_mfma_f32_32x32x16_bf16 v[68:83], a[176:179], v[108:111], v[68:83]
v_mfma_f32_32x32x16_bf16 v[144:159], a[180:183], v[108:111], v[144:159]
v_mfma_f32_32x32x16_bf16 v[128:143], a[176:179], v[112:115], v[128:143]
v_mfma_f32_32x32x16_bf16 v[160:175], a[180:183], v[112:115], v[160:175]
s_waitcnt vmcnt(10)
v_mfma_f32_32x32x16_bf16 v[68:83], a[184:187], v[116:119], v[68:83]
v_mfma_f32_32x32x16_bf16 v[144:159], a[188:191], v[116:119], v[144:159]
v_mfma_f32_32x32x16_bf16 v[128:143], a[184:187], v[120:123], v[128:143]
v_mfma_f32_32x32x16_bf16 v[160:175], a[188:191], v[120:123], v[160:175]
s_waitcnt vmcnt(8)
v_mfma_f32_32x32x16_bf16 v[68:83], a[192:195], v[8:11], v[68:83]
v_mfma_f32_32x32x16_bf16 v[144:159], a[196:199], v[8:11], v[144:159]
v_mfma_f32_32x32x16_bf16 v[128:143], a[192:195], v[12:15], v[128:143]
v_mfma_f32_32x32x16_bf16 v[160:175], a[196:199], v[12:15], v[160:175]
s_waitcnt vmcnt(6)
v_mfma_f32_32x32x16_bf16 v[68:83], a[200:203], v[16:19], v[68:83]
v_mfma_f32_32x32x16_bf16 v[144:159], a[204:207], v[16:19], v[144:159]
v_mfma_f32_32x32x16_bf16 v[128:143], a[200:203], v[20:23], v[128:143]
v_mfma_f32_32x32x16_bf16 v[160:175], a[204:207], v[20:23], v[160:175]
s_waitcnt vmcnt(4)
v_mfma_f32_32x32x16_bf16 v[68:83], a[208:211], v[24:27], v[68:83]
v_mfma_f32_32x32x16_bf16 v[144:159], a[212:215], v[24:27], v[144:159]
v_mfma_f32_32x32x16_bf16 v[128:143], a[208:211], v[28:31], v[128:143]
v_mfma_f32_32x32x16_bf16 v[160:175], a[212:215], v[28:31], v[160:175]
s_waitcnt vmcnt(2)
v_mfma_f32_32x32x16_bf16 v[68:83], a[216:219], v[32:35], v[68:83]
v_mfma_f32_32x32x16_bf16 v[144:159], a[220:223], v[32:35], v[144:159]
v_mfma_f32_32x32x16_bf16 v[128:143], a[216:219], v[36:39], v[128:143]
v_mfma_f32_32x32x16_bf16 v[160:175], a[220:223], v[36:39], v[160:175]
s_waitcnt vmcnt(0)
v_max3_u32 v5, v124, v125, v126
v_max3_u32 v5, v5, v127, v192
v_max3_u32 v5, v5, v193, v194
v_max_u32 v5, v5, v195
v_cmp_eq_u32 vcc, -1, v5
s_nop 0
s_cbranch_vccnz L_sq_12
L_sr_13:
ds_write_b128 v7, v[124:127]
ds_write_b128 v7, v[192:195] offset:1024
s_nop 2
ds_write_b128 v41, v[128:131] offset:0
ds_write_b128 v41, v[132:135] offset:1024
ds_write_b128 v41, v[136:139] offset:2048
ds_write_b128 v41, v[140:143] offset:3072
ds_write_b128 v42, v[144:147] offset:0
ds_write_b128 v42, v[148:151] offset:1024
ds_write_b128 v42, v[152:155] offset:2048
ds_write_b128 v42, v[156:159] offset:3072
ds_write_b128 v43, v[160:163] offset:0
ds_write_b128 v43, v[164:167] offset:1024
ds_write_b128 v43, v[168:171] offset:2048
ds_write_b128 v43, v[172:175] offset:3072
v_mov_b32 v24, v85
s_waitcnt lgkmcnt(0)
s_barrier
s_mov_b32 s72, 0xbfb8aa3b
s_mov_b32 s73, 0xbfb8aa3b
ds_read_b128 v[128:131], v40 offset:0
ds_read_b128 v[144:147], v40 offset:4096
ds_read_b128 v[160:163], v40 offset:8192
ds_read_b64_tr_b16 v[8:9], v44 offset:0
ds_read_b64 v[16:17], v45
ds_read_b128 v[132:135], v40 offset:1024
ds_read_b128 v[148:151], v40 offset:5120
ds_read_b128 v[164:167], v40 offset:9216
ds_read_b64_tr_b16 v[10:11], v44 offset:1024
ds_read_b64 v[18:19], v46
ds_read_b128 v[136:139], v40 offset:2048
ds_read_b128 v[152:155], v40 offset:6144
ds_read_b128 v[168:171], v40 offset:10240
ds_read_b64_tr_b16 v[12:13], v44 offset:2048
ds_read_b64 v[20:21], v47
s_waitcnt lgkmcnt(11)
ds_read_b128 v[140:143], v40 offset:3072
ds_read_b128 v[156:159], v40 offset:7168
ds_read_b128 v[172:175], v40 offset:11264
ds_read_b64_tr_b16 v[14:15], v44 offset:3072
s_waitcnt lgkmcnt(11)
ds_read_b64 v[22:23], v48
s_waitcnt lgkmcnt(10)
v_pk_add_f32 v[68:69], v[68:69], v[128:129]
v_pk_add_f32 v[70:71], v[70:71], v[130:131]
v_pk_add_f32 v[72:73], v[72:73], v[132:133]
v_pk_add_f32 v[74:75], v[74:75], v[134:135]
v_pk_add_f32 v[68:69], v[68:69], v[144:145]
v_pk_add_f32 v[70:71], v[70:71], v[146:147]
v_pk_add_f32 v[72:73], v[72:73], v[148:149]
v_pk_add_f32 v[74:75], v[74:75], v[150:151]
v_pk_add_f32 v[68:69], v[68:69], v[160:161]
v_pk_add_f32 v[70:71], v[70:71], v[162:163]
v_pk_add_f32 v[72:73], v[72:73], v[164:165]
v_pk_add_f32 v[74:75], v[74:75], v[166:167]
v_pk_mul_f32 v[68:69], v[68:69], v[24:25] op_sel_hi:[1,0]
v_pk_mul_f32 v[70:71], v[70:71], v[24:25] op_sel_hi:[1,0]
v_pk_mul_f32 v[72:73], v[72:73], v[24:25] op_sel_hi:[1,0]
v_pk_mul_f32 v[74:75], v[74:75], v[24:25] op_sel_hi:[1,0]
v_pk_mul_f32 v[26:27], v[68:69], s[72:73]
v_pk_mul_f32 v[28:29], v[70:71], s[72:73]
v_pk_mul_f32 v[30:31], v[72:73], s[72:73]
v_pk_mul_f32 v[32:33], v[74:75], s[72:73]
v_exp_f32 v26, v26
v_exp_f32 v27, v27
v_exp_f32 v28, v28
v_exp_f32 v29, v29
v_exp_f32 v30, v30
v_exp_f32 v31, v31
v_exp_f32 v32, v32
v_exp_f32 v33, v33
v_lshlrev_b32 v88, 16, v8
v_and_b32 v89, 0xffff0000, v8
v_lshlrev_b32 v90, 16, v9
v_and_b32 v91, 0xffff0000, v9
v_lshlrev_b32 v92, 16, v10
v_and_b32 v93, 0xffff0000, v10
v_lshlrev_b32 v94, 16, v11
v_and_b32 v95, 0xffff0000, v11
v_pk_add_f32 v[26:27], v[26:27], 1.0 op_sel_hi:[1,0]
v_pk_add_f32 v[28:29], v[28:29], 1.0 op_sel_hi:[1,0]
v_pk_add_f32 v[30:31], v[30:31], 1.0 op_sel_hi:[1,0]
v_pk_add_f32 v[32:33], v[32:33], 1.0 op_sel_hi:[1,0]
v_rcp_f32 v26, v26
v_rcp_f32 v27, v27
v_rcp_f32 v28, v28
v_rcp_f32 v29, v29
v_rcp_f32 v30, v30
v_rcp_f32 v31, v31
v_rcp_f32 v32, v32
v_rcp_f32 v33, v33
v_lshlrev_b32 v96, 16, v16
v_and_b32 v97, 0xffff0000, v16
v_lshlrev_b32 v98, 16, v17
v_and_b32 v99, 0xffff0000, v17
v_lshlrev_b32 v100, 16, v18
v_and_b32 v101, 0xffff0000, v18
v_lshlrev_b32 v102, 16, v19
v_and_b32 v103, 0xffff0000, v19
v_pk_mul_f32 v[68:69], v[68:69], v[26:27]
v_pk_mul_f32 v[70:71], v[70:71], v[28:29]
v_pk_mul_f32 v[72:73], v[72:73], v[30:31]
v_pk_mul_f32 v[74:75], v[74:75], v[32:33]
v_pk_fma_f32 v[68:69], v[68:69], v[88:89], v[96:97]
v_pk_fma_f32 v[70:71], v[70:71], v[90:91], v[98:99]
v_pk_fma_f32 v[72:73], v[72:73], v[92:93], v[100:101]
v_pk_fma_f32 v[74:75], v[74:75], v[94:95], v[102:103]
v_cvt_pk_bf16_f32 v34, v68, v69
v_cvt_pk_bf16_f32 v35, v70, v71
v_cvt_pk_bf16_f32 v36, v72, v73
v_cvt_pk_bf16_f32 v37, v74, v75
ds_write_b64 v45, v[34:35]
ds_write_b64 v46, v[36:37]
s_waitcnt lgkmcnt(2)
v_pk_add_f32 v[76:77], v[76:77], v[136:137]
v_pk_add_f32 v[78:79], v[78:79], v[138:139]
v_pk_add_f32 v[80:81], v[80:81], v[140:141]
v_pk_add_f32 v[82:83], v[82:83], v[142:143]
v_pk_add_f32 v[76:77], v[76:77], v[152:153]
v_pk_add_f32 v[78:79], v[78:79], v[154:155]
v_pk_add_f32 v[80:81], v[80:81], v[156:157]
v_pk_add_f32 v[82:83], v[82:83], v[158:159]
v_pk_add_f32 v[76:77], v[76:77], v[168:169]
v_pk_add_f32 v[78:79], v[78:79], v[170:171]
v_pk_add_f32 v[80:81], v[80:81], v[172:173]
v_pk_add_f32 v[82:83], v[82:83], v[174:175]
v_pk_mul_f32 v[76:77], v[76:77], v[24:25] op_sel_hi:[1,0]
v_pk_mul_f32 v[78:79], v[78:79], v[24:25] op_sel_hi:[1,0]
v_pk_mul_f32 v[80:81], v[80:81], v[24:25] op_sel_hi:[1,0]
v_pk_mul_f32 v[82:83], v[82:83], v[24:25] op_sel_hi:[1,0]
v_pk_mul_f32 v[26:27], v[76:77], s[72:73]
v_pk_mul_f32 v[28:29], v[78:79], s[72:73]
v_pk_mul_f32 v[30:31], v[80:81], s[72:73]
v_pk_mul_f32 v[32:33], v[82:83], s[72:73]
v_exp_f32 v26, v26
v_exp_f32 v27, v27
v_exp_f32 v28, v28
v_exp_f32 v29, v29
v_exp_f32 v30, v30
v_exp_f32 v31, v31
v_exp_f32 v32, v32
v_exp_f32 v33, v33
v_lshlrev_b32 v88, 16, v12
v_and_b32 v89, 0xffff0000, v12
v_lshlrev_b32 v90, 16, v13
v_and_b32 v91, 0xffff0000, v13
v_lshlrev_b32 v92, 16, v14
v_and_b32 v93, 0xffff0000, v14
v_lshlrev_b32 v94, 16, v15
v_and_b32 v95, 0xffff0000, v15
v_pk_add_f32 v[26:27], v[26:27], 1.0 op_sel_hi:[1,0]
v_pk_add_f32 v[28:29], v[28:29], 1.0 op_sel_hi:[1,0]
v_pk_add_f32 v[30:31], v[30:31], 1.0 op_sel_hi:[1,0]
v_pk_add_f32 v[32:33], v[32:33], 1.0 op_sel_hi:[1,0]
v_rcp_f32 v26, v26
v_rcp_f32 v27, v27
v_rcp_f32 v28, v28
v_rcp_f32 v29, v29
v_rcp_f32 v30, v30
v_rcp_f32 v31, v31
v_rcp_f32 v32, v32
v_rcp_f32 v33, v33
v_lshlrev_b32 v96, 16, v20
v_and_b32 v97, 0xffff0000, v20
v_lshlrev_b32 v98, 16, v21
v_and_b32 v99, 0xffff0000, v21
v_lshlrev_b32 v100, 16, v22
v_and_b32 v101, 0xffff0000, v22
v_lshlrev_b32 v102, 16, v23
v_and_b32 v103, 0xffff0000, v23
v_pk_mul_f32 v[76:77], v[76:77], v[26:27]
v_pk_mul_f32 v[78:79], v[78:79], v[28:29]
v_pk_mul_f32 v[80:81], v[80:81], v[30:31]
v_pk_mul_f32 v[82:83], v[82:83], v[32:33]
v_pk_fma_f32 v[76:77], v[76:77], v[88:89], v[96:97]
v_pk_fma_f32 v[78:79], v[78:79], v[90:91], v[98:99]
v_pk_fma_f32 v[80:81], v[80:81], v[92:93], v[100:101]
v_pk_fma_f32 v[82:83], v[82:83], v[94:95], v[102:103]
v_cvt_pk_bf16_f32 v34, v76, v77
v_cvt_pk_bf16_f32 v35, v78, v79
v_cvt_pk_bf16_f32 v36, v80, v81
v_cvt_pk_bf16_f32 v37, v82, v83
ds_write_b64 v47, v[34:35]
ds_write_b64 v48, v[36:37]
s_waitcnt lgkmcnt(0)
s_barrier
ds_read_b128 v[124:127], v3
ds_read_b128 v[192:195], v4
s_add_u32 s57, s12, 8192
s_waitcnt lgkmcnt(0)
buffer_store_dwordx4 v[124:127], v56, s[16:19], s12 offen sc1
buffer_store_dwordx4 v[192:195], v56, s[16:19], s57 offen sc1
s_endpgm
L_non_2:
s_memrealtime s[72:73]
s_waitcnt lgkmcnt(0)
s_or_b32 s72, s72, 1
v_mov_b32 v18, s72
v_mov_b32 v19, s73
v_mov_b32 v28, 0
s_mov_b64 exec, 1
global_store_dwordx2 v28, v[18:19], s[30:31] sc1
s_mov_b64 exec, -1
s_nop 4
s_branch L_nonb_3
L_np_4:
s_mov_b32 s60, 0
L_np_4_l:
global_load_dwordx2 v[222:223], v232, s[30:31] sc1
s_waitcnt vmcnt(0)
v_readfirstlane_b32 s58, v222
v_readfirstlane_b32 s59, v223
s_add_u32 s60, s60, 1
s_cmp_lg_u32 s58, 0
s_cbranch_scc1 L_nd_5
s_cmp_gt_u32 s60, 131072
s_cbranch_scc1 L_nd_5
s_sleep 2
s_branch L_np_4_l
L_sp_6:
s_mov_b32 s60, 0
L_sp_6_l:
buffer_load_dwordx4 v[188:191], v20, s[48:51], 0 offen sc1
buffer_load_dwordx4 v[192:195], v20, s[48:51], 0 offen offset:512 sc1
s_waitcnt vmcnt(0)
v_cmp_eq_u64 vcc, s[58:59], v[190:191]
v_cmp_eq_u64 s[70:71], s[58:59], v[194:195]
s_nop 1
s_and_b64 vcc, vcc, s[70:71]
s_cmp_eq_u64 vcc, exec
s_cbranch_scc1 L_sd_7
s_add_u32 s60, s60, 1
s_cmp_gt_u32 s60, 131072
s_cbranch_scc1 L_sd_7
s_sleep 1
s_branch L_sp_6_l
L_pp_8:
s_mov_b32 s60, 0
L_pp_8_l:
buffer_load_dwordx2 v[220:221], v66, s[48:51], 0 offen offset:0 sc1
buffer_load_dwordx2 v[222:223], v66, s[48:51], 0 offen offset:512 sc1
buffer_load_dwordx2 v[224:225], v66, s[48:51], 0 offen offset:1024 sc1
buffer_load_dwordx2 v[226:227], v66, s[48:51], 0 offen offset:1536 sc1
s_waitcnt vmcnt(0)
v_cmp_eq_u64 vcc, s[58:59], v[220:221]
v_cmp_eq_u64 s[70:71], s[58:59], v[222:223]
s_nop 1
s_and_b64 vcc, vcc, s[70:71]
v_cmp_eq_u64 s[70:71], s[58:59], v[224:225]
s_nop 1
s_and_b64 vcc, vcc, s[70:71]
v_cmp_eq_u64 s[70:71], s[58:59], v[226:227]
s_nop 1
s_and_b64 vcc, vcc, s[70:71]
s_nop 1
s_cmp_eq_u64 vcc, exec
s_cbranch_scc1 L_pd_9
s_add_u32 s60, s60, 1
s_cmp_gt_u32 s60, 131072
s_cbranch_scc1 L_pd_9
s_sleep 1
s_branch L_pp_8_l
L_pp_10:
s_mov_b32 s60, 0
L_pp_10_l:
buffer_load_dwordx2 v[66:67], v52, s[48:51], 0 offen offset:0 sc1
s_waitcnt vmcnt(0)
v_cmp_eq_u64 vcc, s[58:59], v[66:67]
s_nop 1
s_cmp_eq_u64 vcc, exec
s_cbranch_scc1 L_pd_11
s_add_u32 s60, s60, 1
s_cmp_gt_u32 s60, 131072
s_cbranch_scc1 L_pd_11
s_sleep 1
s_branch L_pp_10_l
L_sq_12:
s_mov_b32 s60, 0
L_sq_12_l:
buffer_load_dwordx4 v[124:127], v57, s[48:51], s13 offen sc1
buffer_load_dwordx4 v[192:195], v57, s[48:51], s14 offen sc1
s_waitcnt vmcnt(0)
v_max3_u32 v5, v124, v125, v126
v_max3_u32 v5, v5, v127, v192
v_max3_u32 v5, v5, v193, v194
v_max_u32 v5, v5, v195
v_cmp_eq_u32 vcc, -1, v5
s_add_u32 s60, s60, 1
s_cmp_gt_u32 s60, 131072
s_cbranch_scc1 L_sr_13
s_cbranch_vccnz L_sq_12_l
s_nop 4
s_branch L_sr_13
L_codeend:
L_end:

s_endpgm
.section .rodata,"a"
.p2align 6
.amdhsa_kernel recurrent_scan__ssm_conv_s4__dense_activation_silu__prompt_kernel
  .amdhsa_next_free_vgpr 512
  .amdhsa_next_free_sgpr 102
  .amdhsa_accum_offset 256
  .amdhsa_group_segment_fixed_size 0
  .amdhsa_kernarg_size 120
  .amdhsa_user_sgpr_count 2
  .amdhsa_user_sgpr_kernarg_segment_ptr 1
  .amdhsa_system_sgpr_workgroup_id_x 1
  .amdhsa_float_denorm_mode_32 3
  .amdhsa_float_denorm_mode_16_64 3
.end_amdhsa_kernel
```
